```python
import torch

def _softmax(x, axis=-1):
    return torch.softmax(x, dim=axis)
def _gelu(x):
    return torch.nn.functional.gelu(x, approximate="tanh")
def _silu(x):
    return torch.nn.functional.silu(x)
def _sigmoid(x):
    return torch.sigmoid(x)
def _layernorm(x, axis=-1, eps=1e-5):
    m = x.mean(dim=axis, keepdim=True)
    v = x.var(dim=axis, keepdim=True, unbiased=False)
    return (x - m) / torch.sqrt(v + eps)
def _scatter_add(tgt, idx, src, axis=0):
    return tgt.clone().index_add_(axis, idx, src)
def _segment_sum(src, seg, n):
    out = torch.zeros((n,) + src.shape[1:], dtype=src.dtype)
    return out.index_add_(0, seg, src)
def _pad(x, pw):
    flat = tuple(v for pair in reversed(pw) for v in pair)
    return torch.nn.functional.pad(x, flat)

kernel_name = 'parallel_sum__ssm_conv_s5__mixer_channel_mlp__prompt'

def setup_inputs():

    _w = (lambda a: (lambda t: t.to(torch.bfloat16) if t.is_floating_point() else t)(torch.as_tensor(a)))
    def _A_setup():
        B, S, D = 1, 2048, 512
        P = D
        Lambda_re = -0.5 * (lambda _x: torch.exp(torch.as_tensor(_x)))((lambda *s: torch.randn(*s, dtype=torch.bfloat16) * 0.2)(P))
        Lambda_im = (lambda *s: torch.randn(*s, dtype=torch.bfloat16) * 0.8)(P) * 1.0
        B_re = (lambda *s: torch.randn(*s, dtype=torch.bfloat16) * 0.2)(P, D) * (D ** -0.5)
        B_im = (lambda *s: torch.randn(*s, dtype=torch.bfloat16) * 0.2)(P, D) * (D ** -0.5)
        C_re = (lambda *s: torch.randn(*s, dtype=torch.bfloat16) * 0.2)(D, P) * (P ** -0.5)
        C_im = (lambda *s: torch.randn(*s, dtype=torch.bfloat16) * 0.2)(D, P) * (P ** -0.5)
        log_dt = (lambda *s: torch.randn(*s, dtype=torch.bfloat16) * 0.2)(P) * 0.3 - 2.0
        Dskip = (lambda *s: torch.randn(*s, dtype=torch.bfloat16) * 0.05)(D)
        return {
            "x": _w((lambda *s: torch.randn(*s, dtype=torch.bfloat16) * 0.05)(B, S, D)),
            "Lambda_re": _w(Lambda_re),
            "Lambda_im": _w(Lambda_im),
            "B_re": _w(B_re),
            "B_im": _w(B_im),
            "C_re": _w(C_re),
            "C_im": _w(C_im),
            "log_dt": _w(log_dt),
            "Dskip": _w(Dskip),
        }
    _A_in = _A_setup()

    def _B_setup():
        B, S, D, F = 1, 2048, 512, 1792
        return {
            "x": _w((lambda *s: torch.randn(*s, dtype=torch.bfloat16) * 0.05)(B, S, D)),
            "w1": _w((lambda *s: torch.randn(*s, dtype=torch.bfloat16) * 1.6)(D, F) * (D ** -0.5)),
            "b1": _w((lambda *s: torch.randn(*s, dtype=torch.bfloat16) * 0.8)(F)),
            "w2": _w((lambda *s: torch.randn(*s, dtype=torch.bfloat16) * 0.05)(F, D) * (F ** -0.5)),
            "b2": _w((lambda *s: torch.randn(*s, dtype=torch.bfloat16) * 0.05)(D)),
        }
    _B_in = _B_setup()

    return {
        "A_x": _A_in["x"],
        "A_Lambda_re": _A_in["Lambda_re"],
        "A_Lambda_im": _A_in["Lambda_im"],
        "A_B_re": _A_in["B_re"],
        "A_B_im": _A_in["B_im"],
        "A_C_re": _A_in["C_re"],
        "A_C_im": _A_in["C_im"],
        "A_log_dt": _A_in["log_dt"],
        "A_Dskip": _A_in["Dskip"],
        "B_x": _B_in["x"],
        "B_w1": _B_in["w1"],
        "B_b1": _B_in["b1"],
        "B_w2": _B_in["w2"],
        "B_b2": _B_in["b2"],
    }

def reference(A_x, A_Lambda_re, A_Lambda_im, A_B_re, A_B_im, A_C_re, A_C_im, A_log_dt, A_Dskip, B_x, B_w1, B_b1, B_w2, B_b2):
    def _A_ref(x, Lambda_re, Lambda_im, B_re, B_im, C_re, C_im, log_dt, Dskip):
        Bsz, L, H = x.shape
        Lam = Lambda_re + 1j * Lambda_im
        Bmat = B_re + 1j * B_im
        Cmat = C_re + 1j * C_im
        dt = torch.exp(log_dt)
        Lam_bar = torch.exp(dt * Lam)
        B_bar = ((Lam_bar - 1.0) / Lam)[:, None] * Bmat
        Bu = torch.einsum("bld,pd->blp", x + 0j, B_bar)
        h = torch.zeros_like(Bu[:, 0, :])
        hs = []
        for t in range(L):
            h = Lam_bar[None, :] * h + Bu[:, t, :]
            hs.append(h)
        hseq = torch.stack(hs, 1)
        y = 2.0 * torch.einsum("blp,dp->bld", hseq, Cmat).real + x * Dskip[None, None, :]
        return y

    def _B_ref(x, w1, b1, w2, b2):
        y = _layernorm(x, axis=-1)
        h = _gelu(torch.einsum("bsd,df->bsf", y, w1) + b1)
        return torch.einsum("bsf,fd->bsd", h, w2) + b2

    x = A_x
    xn = _layernorm(x, axis=-1)
    return x + _A_ref(xn, A_Lambda_re, A_Lambda_im, A_B_re, A_B_im, A_C_re, A_C_im, A_log_dt, A_Dskip) + _B_ref(xn, B_w1, B_b1, B_w2, B_b2)
```

```asm
; @launch grid=(256,1,1) block=(256,1,1) lds=163840
.amdgcn_target "amdgcn-amd-amdhsa--gfx950"
.text
.globl parallel_sum__ssm_conv_s5__mixer_channel_mlp__prompt_kernel
.p2align 8
.type parallel_sum__ssm_conv_s5__mixer_channel_mlp__prompt_kernel,@function
parallel_sum__ssm_conv_s5__mixer_channel_mlp__prompt_kernel:
    s_cmp_ge_u32 s2, 256
    s_cbranch_scc1 L_end
    s_load_dwordx16 s[4:19], s[0:1], 0
    s_load_dwordx16 s[20:35], s[0:1], 64
    s_load_dwordx2 s[36:37], s[0:1], 128
    v_lshrrev_b32 v243, 6, v0
    v_and_b32 v242, 63, v0
    v_readfirstlane_b32 s88, v243
    s_getpc_b64 s[56:57]
L_pc:
    s_and_b32 s96, s2, 0xf8
    v_lshrrev_b32 v244, 5, v0
    v_add_lshl_u32 v136, s96, v244, 7
    v_mov_b32 v137, 0
    v_min_u32 v136, L_end-L_pc, v136
    v_lshl_add_u64 v[136:137], v[136:137], 0, s[56:57]
    global_load_dword v138, v[136:137], off
    s_bfe_u32 s95, s2, 0x20003
    s_lshr_b32 s94, s2, 5
    s_and_b32 s89, s2, 3
    s_lshl2_add_u32 s89, s89, s95
    s_and_b32 s90, s2, 4
    s_lshl1_add_u32 s90, s90, s94
    s_lshl2_add_u32 s99, s89, s88
    s_lshl_b32 s38, s99, 15
    s_lshl_b32 s3, s88, 13
    v_lshrrev_b32 v191, 4, v242
    v_xor_b32 v191, v242, v191
    v_and_b32 v191, 7, v191
    v_lshlrev_b32 v191, 4, v191
    v_bfe_u32 v246, v242, 3, 2
    v_lshl_or_b32 v191, v246, 10, v191
    v_lshrrev_b32 v248, 5, v242
    v_lshl_or_b32 v192, v248, 14, v191
    v_xor_b32 v193, 64, v192
    v_add_u32 v194, 6144, v192
    v_add_u32 v195, 9216, v193
    v_add_u32 v193, 3072, v193
    s_mov_b32 s42, 2097152
    s_mov_b32 s43, 0x20000
    s_add_u32 m0, s3, 32768
    s_xor_b32 s94, s38, 0
    s_lshl4_add_u32 s96, s89, s90
    s_lshl2_add_u32 s96, s96, s88
    s_lshl_b32 s96, s96, 11
    v_and_b32 v144, 15, v242
    v_lshl_add_u32 v144, v144, 7, s96
    s_waitcnt lgkmcnt(0)
    global_load_dword v144, v144, s[4:5]
    s_mov_b64 s[40:41], s[4:5]
    buffer_load_dwordx4 v192, s[40:43], s94 offen offset:0 lds
    buffer_load_dwordx4 v193, s[40:43], s94 offen offset:1024 lds
    buffer_load_dwordx4 v194, s[40:43], s94 offen offset:2048 lds
    buffer_load_dwordx4 v195, s[40:43], s94 offen offset:3072 lds
    s_lshr_b32 s92, s90, 2
    s_and_b32 s91, s90, 3
    s_mul_i32 s39, s92, 7
    s_lshl1_add_u32 s39, s91, s39
    s_lshl_b32 s39, s39, 7
    s_cmp_lt_u32 s91, 3
    s_cselect_b32 s95, 128, 0
    v_and_b32 v243, 7, v242
    s_and_b32 s96, s90, 7
    s_lshl3_add_u32 s96, s99, s96
    s_lshr_b32 s97, s90, 3
    s_lshl1_add_u32 s96, s96, s97
    s_mul_i32 s96, s96, 1792
    v_min_u32 v139, 13, v242
    v_lshl_add_u32 v139, v139, 7, s96
    s_lshr_b32 s96, s99, 1
    s_lshl_b32 s97, s90, 5
    s_add_u32 s96, s96, s97
    s_lshl_b32 s96, s96, 10
    v_lshl_add_u32 v140, v243, 7, s96
    global_load_dword v139, v139, s[24:25]
    s_bitcmp0_b32 s88, 0
    s_cselect_b64 s[56:57], s[10:11], s[12:13]
    global_load_dword v140, v140, s[56:57]
    v_and_b32 v249, 31, v242
    v_bfe_u32 v244, v242, 2, 1
    v_and_b32 v243, 3, v242
    v_lshl_or_b32 v243, v246, 2, v243
    v_lshl_or_b32 v251, v244, 4, v243
    v_add_lshl_u32 v141, v251, s97, 1
    v_and_b32 v243, 0x33, v242
    v_lshl_or_b32 v243, v244, 3, v243
    v_and_b32 v191, 1, v246
    v_lshl_or_b32 v243, v191, 2, v243
    v_lshl_add_u32 v142, v243, 1, s39
    v_add_u32 v143, s95, v142
    global_load_ushort v212, v141, s[6:7]
    global_load_ushort v213, v141, s[8:9]
    global_load_ushort v214, v141, s[18:19]
    global_load_ushort v226, v142, s[26:27]
    global_load_ushort v228, v143, s[26:27]
    v_lshlrev_b32 v206, 4, v242
    s_mov_b64 s[60:61], s[36:37]
    s_mov_b32 s62, 18874368
    s_mov_b32 s63, 0x20000
    v_accvgpr_write_b32 a188, -1
    v_accvgpr_write_b32 a189, -1
    v_accvgpr_write_b32 a190, -1
    v_accvgpr_write_b32 a191, -1
    s_mov_b64 s[80:81], s[34:35]
    s_mov_b32 s82, 256
    s_mov_b32 s83, 0x20000
    s_lshl2_add_u32 s34, s91, s88
    s_lshl2_add_u32 s35, s89, s92
    v_accvgpr_write_b32 a172, 0
    v_accvgpr_write_b32 a173, 0
    v_accvgpr_write_b32 a174, 0
    v_accvgpr_write_b32 a175, 0
    s_cmp_lg_u32 s34, 15
    s_cbranch_scc1 L_noinit
    s_lshl_b32 s95, s35, 10
    s_add_u32 s95, s95, 14417920
    buffer_store_dwordx4 a[188:191], v206, s[60:63], s95 offen sc1
    s_lshl_b32 s95, s35, 11
    s_add_u32 s95, s95, 14483456
    buffer_store_dwordx4 a[172:175], v206, s[60:63], s95 offen offset:0 sc1
    buffer_store_dwordx4 a[172:175], v206, s[60:63], s95 offen offset:1024 sc1
L_noinit:
    s_mov_b64 s[72:73], s[36:37]
    s_mov_b32 s74, 18874368
    s_mov_b32 s75, 0x20000
    s_lshr_b32 s95, s90, 3
    s_and_b32 s96, s90, 7
    s_mul_i32 s1, s95, 14
    s_add_u32 s1, s1, s89
    s_lshl1_add_u32 s1, s1, s88
    s_lshl3_add_u32 s1, s1, s96
    s_cmp_lt_u32 s89, 14
    s_cselect_b32 s58, 1835008, 0
    s_cselect_b32 s1, s1, 0
    s_and_b32 s94, s89, 1
    s_lshl1_add_u32 s94, s96, s94
    s_lshl1_add_u32 s94, s94, s95
    s_bfe_u32 s95, s89, 0x20001
    s_lshl2_add_u32 s94, s94, s95
    s_bitcmp0_b32 s89, 3
    s_cselect_b64 s[56:57], s[14:15], s[16:17]
    s_cselect_b64 s[84:85], s[20:21], s[30:31]
    s_cmp_lt_u32 s88, 2
    s_cselect_b64 s[56:57], s[28:29], s[56:57]
    s_cselect_b32 s58, s58, 524288
    s_cselect_b32 s1, s1, s94
    s_mov_b32 s59, 0x20000
    s_cmp_eq_u32 s58, 0
    s_cselect_b32 s74, 0, s74
    s_lshr_b32 s94, s1, 3
    s_lshl_b32 s94, s94, 8
    s_cmp_eq_u32 s88, 3
    s_cselect_b64 s[56:57], s[84:85], s[56:57]
    s_cselect_b32 s58, 1024, s58
    s_cselect_b32 s74, 0, s74
    s_cselect_b32 s94, 0, s94
    s_and_b32 s95, s1, 7
    s_or_b32 s94, s94, s95
    s_lshl_b32 s0, s94, 7
    s_mul_i32 s99, s99, 180224
    s_mul_i32 s94, s92, 11
    s_add_u32 s94, s94, s91
    s_lshl_b32 s94, s94, 12
    s_add_u32 s99, s99, s94
    s_and_b32 s95, s1, 7
    s_lshr_b32 s94, s1, 3
    s_cmp_ge_u32 s88, 2
    s_cbranch_scc1 L_dst2
    s_mul_i32 s97, s95, 352
    s_and_b32 s96, s94, 1
    s_lshl1_add_u32 s97, s96, s97
    s_lshl3_add_u32 s101, s95, s96
    s_lshr_b32 s94, s94, 1
    s_lshl4_add_u32 s101, s101, s94
    s_mul_i32 s95, s94, 37
    s_lshr_b32 s95, s95, 8
    s_mul_i32 s96, s95, 25
    s_add_u32 s101, s101, s96
    s_mul_i32 s96, s95, 44
    s_add_u32 s97, s97, s96
    s_mul_i32 s95, s95, 7
    s_sub_u32 s94, s94, s95
    s_lshr_b32 s95, s94, 1
    s_and_b32 s94, s94, 1
    s_lshl2_add_u32 s94, s94, s95
    s_lshl2_add_u32 s97, s94, s97
    s_movk_i32 s98, 176
    s_branch L_dstjoin
L_dst2:
    s_lshr_b32 s101, s94, 1
    s_lshr_b32 s96, s95, 1
    s_lshl2_add_u32 s101, s101, s96
    s_lshr_b32 s97, s89, 3
    s_lshl1_add_u32 s101, s101, s97
    s_and_b32 s97, s94, 1
    s_lshl3_add_u32 s101, s101, s97
    s_and_b32 s97, s95, 1
    s_lshl1_add_u32 s101, s101, s97
    s_add_u32 s101, s101, 7
    s_mul_i32 s97, s94, 176
    s_mul_i32 s96, s96, 44
    s_add_u32 s97, s97, s96
    s_and_b32 s95, s95, 1
    s_lshl3_add_u32 s97, s95, s97
    s_lshr_b32 s95, s89, 3
    s_lshl1_add_u32 s97, s95, s97
    s_add_u32 s97, s97, 28
    s_movk_i32 s98, 4
L_dstjoin:
    s_add_u32 s97, s97, 11264
    s_add_u32 s98, s98, s97
    s_lshl_b32 s97, s97, 10
    s_lshl_b32 s98, s98, 10
    s_lshl2_add_u32 s101, s101, 14581760
    s_mov_b64 s[44:45], s[10:11]
    s_mov_b32 s46, 524288
    s_mov_b32 s47, 0x20000
    s_mov_b64 s[48:49], s[12:13]
    s_mov_b32 s50, 524288
    s_mov_b32 s51, 0x20000
    s_mov_b64 s[52:53], s[24:25]
    s_mov_b32 s54, 1835008
    s_mov_b32 s55, 0x20000
    s_mov_b64 s[68:69], s[24:25]
    s_mov_b32 s70, 1835008
    s_mov_b32 s71, 0x20000
    s_mov_b64 s[64:65], s[36:37]
    s_mov_b32 s66, 18874368
    s_mov_b32 s67, 0x20000
    s_mov_b64 s[76:77], s[32:33]
    s_mov_b32 s78, 4194304
    s_mov_b32 s79, 0x20000
    s_cmp_lt_u32 s91, 3
    s_cselect_b32 s70, s70, 0
    s_cselect_b32 s66, s66, 0
    s_lshl_b32 s94, s90, 12
    s_add_u32 s94, s94, 14417920
    s_add_u32 s84, s36, s94
    s_addc_u32 s85, s37, 0
    s_mov_b32 s86, 4096
    s_mov_b32 s87, 0x20000
    s_mov_b32 s94, s88
    s_lshl_b32 s26, s90, 8
    s_or_b32 s26, s26, s94
    s_lshl_b32 s26, s26, 7
    s_mul_i32 s27, s94, 229376
    s_add_u32 s27, s27, s39
    s_xor_b32 s94, s94, 4
    s_mul_i32 s28, s94, 229376
    s_add_u32 s28, s28, s39
    s_lshl2_add_u32 s29, s89, s92
    s_lshl4_add_u32 s29, s29, s88
    s_lshl2_add_u32 s29, s29, s91
    s_lshl2_add_u32 s29, s29, 14483456
    s_and_b32 s16, s90, 7
    s_lshr_b32 s95, s90, 3
    s_lshl1_add_u32 s15, s89, s95
    s_lshr_b32 s94, s88, 1
    s_lshl1_add_u32 s19, s95, s94
    s_mul_i32 s94, s19, 22
    s_and_b32 s95, s88, 1
    s_add_u32 s94, s94, s95
    s_lshl_b32 s94, s94, 11
    s_mul_i32 s6, s15, 360448
    s_add_u32 s6, s6, s94
    s_xor_b32 s18, s15, 1
    s_mul_i32 s18, s18, 360448
    s_add_u32 s18, s18, s94
    s_mul_i32 s17, s16, 360448
    s_add_u32 s17, s17, s94
    s_add_u32 s17, s17, 11534336
    s_lshl2_add_u32 s12, s2, s88
    s_lshl_b32 s12, s12, 11
    s_or_b32 s12, s12, 16777216
    s_xor_b32 s13, s12, 32768
    s_add_u32 m0, s3, 36864
    s_xor_b32 s94, s38, 128
    buffer_load_dwordx4 v192, s[40:43], s94 offen offset:0 lds
    buffer_load_dwordx4 v193, s[40:43], s94 offen offset:1024 lds
    buffer_load_dwordx4 v194, s[40:43], s94 offen offset:2048 lds
    buffer_load_dwordx4 v195, s[40:43], s94 offen offset:3072 lds
    v_lshrrev_b32 v243, 3, v242
    v_and_b32 v191, 0x70, v206
    v_bfe_u32 v244, v242, 4, 1
    v_lshlrev_b32 v246, 6, v244
    v_xor_b32 v191, v191, v246
    v_mul_u32_u24 v246, 3584, v243
    v_add_u32 v196, v246, v191
    v_add_u32 v197, 27648, v196
    v_add_u32 v198, 55296, v196
    v_add_u32 v199, 82944, v196
    v_bfe_u32 v243, v242, 2, 2
    v_lshl_or_b32 v191, v248, 3, v243
    v_lshlrev_b32 v191, 7, v191
    v_lshrrev_b32 v243, 1, v243
    v_lshl_or_b32 v191, v243, 6, v191
    v_lshl_or_b32 v191, v244, 5, v191
    v_and_b32 v243, 1, v242
    v_lshl_or_b32 v191, v243, 4, v191
    v_bfe_u32 v243, v242, 1, 1
    v_lshl_or_b32 v204, v243, 3, v191
    v_xor_b32 v205, 64, v204
    v_bfe_u32 v243, v249, 1, 3
    v_xor_b32 v243, v243, v248
    v_lshlrev_b32 v243, 4, v243
    v_lshl_or_b32 v243, v249, 7, v243
    v_add_u32 v200, s3, v243
    v_xor_b32 v201, 32, v200
    v_xor_b32 v202, 64, v200
    v_xor_b32 v203, 96, v200
    v_bfe_u32 v243, v242, 2, 2
    v_lshl_or_b32 v243, v248, 4, v243
    s_add_u32 s94, s3, 131072
    v_lshl_add_u32 v252, v243, 7, s94
    v_and_b32 v243, 1, v242
    v_lshl_or_b32 v252, v243, 5, v252
    v_bfe_u32 v243, v242, 3, 1
    v_xor_b32 v243, v243, v244
    v_lshl_or_b32 v252, v243, 4, v252
    v_bfe_u32 v243, v242, 1, 1
    v_lshl_or_b32 v252, v243, 3, v252
    v_xor_b32 v253, 32, v252
    v_xor_b32 v254, 64, v252
    v_xor_b32 v255, 96, v252
    s_cmp_lt_u32 s88, 2
    s_cbranch_scc1 L_awdone
    v_add_u32 v252, 131072, v200
    v_add_u32 v253, 131072, v201
    v_add_u32 v254, 131072, v202
    v_add_u32 v255, 131072, v203
L_awdone:
    s_lshl_b32 s94, s88, 7
    s_add_u32 s94, s94, 32768
    v_lshl_add_u32 v243, v248, 6, s94
    v_lshl_add_u32 v191, v251, 2, s94
    v_accvgpr_write_b32 a183, v243
    v_accvgpr_write_b32 a184, v191
    s_lshl_b32 s94, s88, 9
    s_add_u32 s94, s94, 33792
    v_lshl_add_u32 v243, v242, 3, s94
    v_accvgpr_write_b32 a185, v243
    s_lshl_b32 s94, s89, 8
    v_lshlrev_b32 v243, 3, v242
    v_subrev_u32 v243, 256, v243
    v_cmp_gt_i32 vcc, 0, v243
    v_add_u32 v191, s94, v243
    s_nop 0
    v_cndmask_b32 v243, v191, v243, vcc
    v_accvgpr_write_b32 a181, v243
    v_lshlrev_b32 v243, 3, v249
    v_lshlrev_b32 v191, 8, v248
    v_sub_u32 v243, v243, v191
    v_add_u32 v243, 110848, v243
    v_accvgpr_write_b32 a182, v243
    s_mul_i32 s94, s88, 5120
    s_add_u32 s94, s94, 131072
    v_mul_u32_u24 v243, 80, v249
    v_lshl_add_u32 v243, v248, 5, v243
    v_add_u32 v243, s94, v243
    v_accvgpr_write_b32 a176, v243
    v_bfe_u32 v243, v242, 2, 2
    v_lshl_add_u32 v243, v248, 4, v243
    v_mul_u32_u24 v191, 80, v243
    v_and_b32 v243, 1, v242
    v_lshl_add_u32 v191, v243, 5, v191
    v_lshl_add_u32 v191, v244, 4, v191
    v_bfe_u32 v243, v242, 1, 1
    v_lshl_add_u32 v191, v243, 3, v191
    v_add_u32 v191, s94, v191
    v_accvgpr_write_b32 a177, v191
    s_mul_i32 s32, s88, 3072
    s_add_u32 s32, s32, 114688
    s_lshl3_add_u32 s33, s15, s88
    s_lshl_b32 s33, s33, 13
    s_lshl_b32 s94, s16, 7
    s_add_u32 s33, s33, s94
    v_mov_b32 v160, s30
    v_mov_b32 v161, s31
    v_cmp_gt_u32 vcc, 8, v242
    v_mov_b32 v162, s20
    v_mov_b32 v163, s21
    v_cndmask_b32 v160, v160, v162, vcc
    v_cndmask_b32 v161, v161, v163, vcc
    v_and_b32 v243, 0x70, v206
    v_add_u32 v162, s94, v243
    v_mov_b32 v163, 0
    v_lshl_add_u64 v[160:161], v[162:163], 0, v[160:161]
    v_lshrrev_b32 v191, 3, v242
    v_lshl_or_b32 v243, v191, 10, v243
    v_accvgpr_write_b32 a179, v160
    v_accvgpr_write_b32 a180, v161
    v_accvgpr_write_b32 a178, v243
    v_and_b32 v239, 3, v242
    v_lshlrev_b32 v239, 14, v239
    s_and_b32 s94, s16, 3
    s_lshl4_add_u32 s94, s94, s89
    s_lshl2_add_u32 s94, s94, s19
    s_lshl_b32 s94, s94, 8
    s_add_u32 s94, s94, 14483456
    s_add_u32 s8, s36, s94
    s_addc_u32 s9, s37, 0
    s_lshl2_add_u32 s94, s2, s88
    s_lshl_b32 s94, s94, 5
    s_add_u32 s94, s94, 14548992
    s_add_u32 s10, s36, s94
    s_addc_u32 s11, s37, 0
    s_xor_b32 s7, s94, 512
    s_and_b32 s94, s89, 7
    s_lshl3_add_u32 s94, s94, s16
    s_lshl2_add_u32 s94, s94, s19
    s_and_b32 s95, s88, 1
    s_lshl1_add_u32 s94, s94, s95
    s_lshl_b32 s94, s94, 6
    s_add_u32 s94, s94, 14581760
    s_add_u32 s4, s36, s94
    s_addc_u32 s5, s37, 0
    v_and_b32 v243, 1, v242
    v_lshlrev_b32 v243, 4, v243
    v_mov_b32 v244, 0x3f80
    v_lshlrev_b32 v243, v243, v244
    v_bfe_u32 v244, v242, 1, 1
    v_mul_lo_u32 v165, v243, v244
    v_sub_u32 v164, v243, v165
    v_mov_b32 v227, 0
    v_mov_b32 v229, 0
    v_mov_b32 v231, 0
    v_mov_b32 v232, 0
    v_mov_b32 v233, 0
    v_mov_b32 v235, 0
    v_mov_b32 v236, 0
    v_mov_b32 v237, 0
    v_mov_b32 v207, 0
    v_mov_b32 v208, 0
    v_lshlrev_b32 v250, 2, v242
    v_and_b32 v238, 7, v242
    v_lshlrev_b32 v238, 12, v238
    v_mov_b32 v240, 1
    v_mov_b32 v241, 0
    s_mov_b32 s100, 0x3f803f80
    s_add_u32 m0, s3, 65536
    s_xor_b32 s94, s38, 256
    buffer_load_dwordx4 v192, s[40:43], s94 offen offset:0 lds
    buffer_load_dwordx4 v193, s[40:43], s94 offen offset:1024 lds
    buffer_load_dwordx4 v194, s[40:43], s94 offen offset:2048 lds
    buffer_load_dwordx4 v195, s[40:43], s94 offen offset:3072 lds
    s_add_u32 m0, s3, 69632
    s_xor_b32 s94, s38, 384
    buffer_load_dwordx4 v192, s[40:43], s94 offen offset:0 lds
    buffer_load_dwordx4 v193, s[40:43], s94 offen offset:1024 lds
    buffer_load_dwordx4 v194, s[40:43], s94 offen offset:2048 lds
    buffer_load_dwordx4 v195, s[40:43], s94 offen offset:3072 lds
    s_add_u32 m0, s3, 98304
    s_xor_b32 s94, s38, 512
    buffer_load_dwordx4 v192, s[40:43], s94 offen offset:0 lds
    buffer_load_dwordx4 v193, s[40:43], s94 offen offset:1024 lds
    buffer_load_dwordx4 v194, s[40:43], s94 offen offset:2048 lds
    buffer_load_dwordx4 v195, s[40:43], s94 offen offset:3072 lds
    s_waitcnt vmcnt(23)
    ds_read_b128 v[0:3], v200 offset:32768
    ds_read_b128 v[4:7], v201 offset:32768
    ds_read_b128 v[8:11], v202 offset:32768
    ds_read_b128 v[12:15], v203 offset:32768
    s_add_u32 m0, s3, 102400
    s_xor_b32 s94, s38, 640
    buffer_load_dwordx4 v192, s[40:43], s94 offen offset:0 lds
    buffer_load_dwordx4 v193, s[40:43], s94 offen offset:1024 lds
    buffer_load_dwordx4 v194, s[40:43], s94 offen offset:2048 lds
    buffer_load_dwordx4 v195, s[40:43], s94 offen offset:3072 lds
    s_waitcnt vmcnt(16)
    ds_read_b128 v[16:19], v200 offset:36864
    ds_read_b128 v[20:23], v201 offset:36864
    ds_read_b128 v[24:27], v202 offset:36864
    ds_read_b128 v[28:31], v203 offset:36864
    s_cmp_lg_u32 s34, 15
    s_cbranch_scc1 L_nogo
    s_lshl_b32 s95, s35, 2
    buffer_store_dword v240, v241, s[80:83], s95 offen sc1
L_nogo:
    s_waitcnt lgkmcnt(4)
    v_dot2c_f32_bf16 v207, s100, v0
    v_dot2c_f32_bf16 v207, s100, v1
    v_dot2c_f32_bf16 v207, s100, v2
    v_dot2c_f32_bf16 v207, s100, v3
    v_dot2c_f32_bf16 v207, s100, v4
    v_dot2c_f32_bf16 v207, s100, v5
    v_dot2c_f32_bf16 v207, s100, v6
    v_dot2c_f32_bf16 v207, s100, v7
    v_dot2c_f32_bf16 v207, s100, v8
    v_dot2c_f32_bf16 v207, s100, v9
    v_dot2c_f32_bf16 v207, s100, v10
    v_dot2c_f32_bf16 v207, s100, v11
    v_dot2c_f32_bf16 v207, s100, v12
    v_dot2c_f32_bf16 v207, s100, v13
    v_dot2c_f32_bf16 v207, s100, v14
    v_dot2c_f32_bf16 v207, s100, v15
    v_dot2c_f32_bf16 v208, v0, v0
    v_dot2c_f32_bf16 v208, v1, v1
    v_dot2c_f32_bf16 v208, v2, v2
    v_dot2c_f32_bf16 v208, v3, v3
    v_dot2c_f32_bf16 v208, v4, v4
    v_dot2c_f32_bf16 v208, v5, v5
    v_dot2c_f32_bf16 v208, v6, v6
    v_dot2c_f32_bf16 v208, v7, v7
    v_dot2c_f32_bf16 v208, v8, v8
    v_dot2c_f32_bf16 v208, v9, v9
    v_dot2c_f32_bf16 v208, v10, v10
    v_dot2c_f32_bf16 v208, v11, v11
    v_dot2c_f32_bf16 v208, v12, v12
    v_dot2c_f32_bf16 v208, v13, v13
    v_dot2c_f32_bf16 v208, v14, v14
    v_dot2c_f32_bf16 v208, v15, v15
    v_lshl_or_b32 v226, v226, 16, v226
    v_lshl_or_b32 v228, v228, 16, v228
    v_lshlrev_b32 v172, 16, v212
    v_lshlrev_b32 v173, 16, v213
    v_lshlrev_b32 v168, 16, v214
    v_mul_f32 v168, 0x3fb8aa3b, v168
    v_exp_f32 v168, v168
    v_cvt_f32_u32 v170, v248
    v_cvt_pk_bf16_f32 v168, v168, v168
    v_and_b32 v168, 0xffff0000, v168
    v_mul_f32 v174, v168, v172
    v_mul_f32 v175, v168, v173
    v_mul_f32 v174, 0x3fb8aa3b, v174
    v_mul_f32 v175, 0.15915494, v175
    v_exp_f32 v168, v174
    v_fract_f32 v169, v175
    v_cos_f32 v212, v169
    s_add_u32 m0, s3, 131072
    s_xor_b32 s94, s38, 768
    buffer_load_dwordx4 v192, s[40:43], s94 offen offset:0 lds
    buffer_load_dwordx4 v193, s[40:43], s94 offen offset:1024 lds
    buffer_load_dwordx4 v194, s[40:43], s94 offen offset:2048 lds
    buffer_load_dwordx4 v195, s[40:43], s94 offen offset:3072 lds
    v_add_u32 v200, 65536, v200
    v_add_u32 v201, 65536, v201
    v_add_u32 v202, 65536, v202
    v_add_u32 v203, 65536, v203
    s_waitcnt vmcnt(16)
    ds_read_b128 v[32:35], v200 offset:0
    ds_read_b128 v[36:39], v201 offset:0
    ds_read_b128 v[40:43], v202 offset:0
    ds_read_b128 v[44:47], v203 offset:0
    s_waitcnt lgkmcnt(4)
    v_dot2c_f32_bf16 v207, s100, v16
    v_dot2c_f32_bf16 v207, s100, v17
    v_dot2c_f32_bf16 v207, s100, v18
    v_dot2c_f32_bf16 v207, s100, v19
    v_dot2c_f32_bf16 v207, s100, v20
    v_dot2c_f32_bf16 v207, s100, v21
    v_dot2c_f32_bf16 v207, s100, v22
    v_dot2c_f32_bf16 v207, s100, v23
    v_dot2c_f32_bf16 v207, s100, v24
    v_dot2c_f32_bf16 v207, s100, v25
    v_dot2c_f32_bf16 v207, s100, v26
    v_dot2c_f32_bf16 v207, s100, v27
    v_dot2c_f32_bf16 v207, s100, v28
    v_dot2c_f32_bf16 v207, s100, v29
    v_dot2c_f32_bf16 v207, s100, v30
    v_dot2c_f32_bf16 v207, s100, v31
    v_dot2c_f32_bf16 v208, v16, v16
    v_dot2c_f32_bf16 v208, v17, v17
    v_dot2c_f32_bf16 v208, v18, v18
    v_dot2c_f32_bf16 v208, v19, v19
    v_dot2c_f32_bf16 v208, v20, v20
    v_dot2c_f32_bf16 v208, v21, v21
    v_dot2c_f32_bf16 v208, v22, v22
    v_dot2c_f32_bf16 v208, v23, v23
    v_dot2c_f32_bf16 v208, v24, v24
    v_dot2c_f32_bf16 v208, v25, v25
    v_dot2c_f32_bf16 v208, v26, v26
    v_dot2c_f32_bf16 v208, v27, v27
    v_dot2c_f32_bf16 v208, v28, v28
    v_dot2c_f32_bf16 v208, v29, v29
    v_dot2c_f32_bf16 v208, v30, v30
    v_dot2c_f32_bf16 v208, v31, v31
    v_sin_f32 v213, v169
    v_mul_f32 v212, v212, v168
    v_mul_f32 v213, v213, v168
    v_mul_f32 v168, 0x41800000, v174
    v_mul_f32 v169, 0x41800000, v175
    v_exp_f32 v168, v168
    v_fract_f32 v169, v169
    v_cos_f32 v216, v169
    v_sin_f32 v217, v169
    v_mul_f32 v216, v216, v168
    v_mul_f32 v217, v217, v168
    v_mul_f32 v168, 0x43800000, v174
    v_mul_f32 v169, 0x43800000, v175
    v_exp_f32 v168, v168
    v_fract_f32 v169, v169
    v_cos_f32 v222, v169
    v_sin_f32 v223, v169
    s_add_u32 m0, s3, 135168
    s_xor_b32 s94, s38, 896
    buffer_load_dwordx4 v192, s[40:43], s94 offen offset:0 lds
    buffer_load_dwordx4 v193, s[40:43], s94 offen offset:1024 lds
    buffer_load_dwordx4 v194, s[40:43], s94 offen offset:2048 lds
    buffer_load_dwordx4 v195, s[40:43], s94 offen offset:3072 lds
    s_waitcnt vmcnt(16)
    ds_read_b128 v[48:51], v200 offset:4096
    ds_read_b128 v[52:55], v201 offset:4096
    ds_read_b128 v[56:59], v202 offset:4096
    ds_read_b128 v[60:63], v203 offset:4096
    s_waitcnt lgkmcnt(4)
    v_dot2c_f32_bf16 v207, s100, v32
    v_dot2c_f32_bf16 v207, s100, v33
    v_dot2c_f32_bf16 v207, s100, v34
    v_dot2c_f32_bf16 v207, s100, v35
    v_dot2c_f32_bf16 v207, s100, v36
    v_dot2c_f32_bf16 v207, s100, v37
    v_dot2c_f32_bf16 v207, s100, v38
    v_dot2c_f32_bf16 v207, s100, v39
    v_dot2c_f32_bf16 v207, s100, v40
    v_dot2c_f32_bf16 v207, s100, v41
    v_dot2c_f32_bf16 v207, s100, v42
    v_dot2c_f32_bf16 v207, s100, v43
    v_dot2c_f32_bf16 v207, s100, v44
    v_dot2c_f32_bf16 v207, s100, v45
    v_dot2c_f32_bf16 v207, s100, v46
    v_dot2c_f32_bf16 v207, s100, v47
    v_dot2c_f32_bf16 v208, v32, v32
    v_dot2c_f32_bf16 v208, v33, v33
    v_dot2c_f32_bf16 v208, v34, v34
    v_dot2c_f32_bf16 v208, v35, v35
    v_dot2c_f32_bf16 v208, v36, v36
    v_dot2c_f32_bf16 v208, v37, v37
    v_dot2c_f32_bf16 v208, v38, v38
    v_dot2c_f32_bf16 v208, v39, v39
    v_dot2c_f32_bf16 v208, v40, v40
    v_dot2c_f32_bf16 v208, v41, v41
    v_dot2c_f32_bf16 v208, v42, v42
    v_dot2c_f32_bf16 v208, v43, v43
    v_dot2c_f32_bf16 v208, v44, v44
    v_dot2c_f32_bf16 v208, v45, v45
    v_dot2c_f32_bf16 v208, v46, v46
    v_dot2c_f32_bf16 v208, v47, v47
    v_mul_f32 v222, v222, v168
    v_mul_f32 v223, v223, v168
    v_mul_f32 v171, 0x43000000, v170
    v_mul_f32 v168, v171, v174
    v_mul_f32 v169, v171, v175
    v_exp_f32 v168, v168
    v_fract_f32 v169, v169
    v_cos_f32 v220, v169
    v_sin_f32 v221, v169
    v_mul_f32 v220, v220, v168
    v_mul_f32 v221, v221, v168
    s_lshl_b32 s93, s88, 1
    v_add_u32 v171, s93, v248
    v_cvt_f32_u32 v171, v171
    v_mul_f32 v171, 0x41800000, v171
    v_mul_f32 v168, v171, v174
    v_mul_f32 v169, v171, v175
    s_add_u32 m0, s3, 0
    s_add_u32 s94, s27, 0
    buffer_load_dwordx4 v196, s[52:55], s94 offen offset:0 lds
    buffer_load_dwordx4 v197, s[52:55], s94 offen offset:1024 lds
    buffer_load_dwordx4 v198, s[52:55], s94 offen offset:2048 lds
    buffer_load_dwordx4 v199, s[52:55], s94 offen offset:3072 lds
    s_waitcnt vmcnt(16)
    ds_read_b128 v[64:67], v200 offset:32768
    ds_read_b128 v[68:71], v201 offset:32768
    ds_read_b128 v[72:75], v202 offset:32768
    ds_read_b128 v[76:79], v203 offset:32768
    s_waitcnt lgkmcnt(4)
    v_dot2c_f32_bf16 v207, s100, v48
    v_dot2c_f32_bf16 v207, s100, v49
    v_dot2c_f32_bf16 v207, s100, v50
    v_dot2c_f32_bf16 v207, s100, v51
    v_dot2c_f32_bf16 v207, s100, v52
    v_dot2c_f32_bf16 v207, s100, v53
    v_dot2c_f32_bf16 v207, s100, v54
    v_dot2c_f32_bf16 v207, s100, v55
    v_dot2c_f32_bf16 v207, s100, v56
    v_dot2c_f32_bf16 v207, s100, v57
    v_dot2c_f32_bf16 v207, s100, v58
    v_dot2c_f32_bf16 v207, s100, v59
    v_dot2c_f32_bf16 v207, s100, v60
    v_dot2c_f32_bf16 v207, s100, v61
    v_dot2c_f32_bf16 v207, s100, v62
    v_dot2c_f32_bf16 v207, s100, v63
    v_dot2c_f32_bf16 v208, v48, v48
    v_dot2c_f32_bf16 v208, v49, v49
    v_dot2c_f32_bf16 v208, v50, v50
    v_dot2c_f32_bf16 v208, v51, v51
    v_dot2c_f32_bf16 v208, v52, v52
    v_dot2c_f32_bf16 v208, v53, v53
    v_dot2c_f32_bf16 v208, v54, v54
    v_dot2c_f32_bf16 v208, v55, v55
    v_dot2c_f32_bf16 v208, v56, v56
    v_dot2c_f32_bf16 v208, v57, v57
    v_dot2c_f32_bf16 v208, v58, v58
    v_dot2c_f32_bf16 v208, v59, v59
    v_dot2c_f32_bf16 v208, v60, v60
    v_dot2c_f32_bf16 v208, v61, v61
    v_dot2c_f32_bf16 v208, v62, v62
    v_dot2c_f32_bf16 v208, v63, v63
    v_exp_f32 v168, v168
    v_fract_f32 v169, v169
    v_cos_f32 v218, v169
    v_sin_f32 v219, v169
    v_mul_f32 v218, v218, v168
    v_mul_f32 v219, v219, v168
    v_mul_f32 v168, v172, v172
    v_fmac_f32 v168, v173, v173
    v_rcp_f32 v168, v168
    v_add_f32 v169, -1.0, v212
    v_mul_f32 v170, v169, v172
    v_fmac_f32 v170, v213, v173
    v_mul_f32 v171, v213, v172
    v_fma_f32 v171, -v169, v173, v171
    v_add_f32 v168, v168, v168
    v_mul_f32 v214, v170, v168
    v_mul_f32 v215, v171, v168
    s_add_u32 m0, s3, 4096
    s_add_u32 s94, s27, 114688
    buffer_load_dwordx4 v196, s[52:55], s94 offen offset:0 lds
    buffer_load_dwordx4 v197, s[52:55], s94 offen offset:1024 lds
    buffer_load_dwordx4 v198, s[52:55], s94 offen offset:2048 lds
    buffer_load_dwordx4 v199, s[52:55], s94 offen offset:3072 lds
    s_waitcnt vmcnt(16)
    ds_read_b128 v[80:83], v200 offset:36864
    ds_read_b128 v[84:87], v201 offset:36864
    ds_read_b128 v[88:91], v202 offset:36864
    ds_read_b128 v[92:95], v203 offset:36864
    s_waitcnt lgkmcnt(4)
    v_dot2c_f32_bf16 v207, s100, v64
    v_dot2c_f32_bf16 v207, s100, v65
    v_dot2c_f32_bf16 v207, s100, v66
    v_dot2c_f32_bf16 v207, s100, v67
    v_dot2c_f32_bf16 v207, s100, v68
    v_dot2c_f32_bf16 v207, s100, v69
    v_dot2c_f32_bf16 v207, s100, v70
    v_dot2c_f32_bf16 v207, s100, v71
    v_dot2c_f32_bf16 v207, s100, v72
    v_dot2c_f32_bf16 v207, s100, v73
    v_dot2c_f32_bf16 v207, s100, v74
    v_dot2c_f32_bf16 v207, s100, v75
    v_dot2c_f32_bf16 v207, s100, v76
    v_dot2c_f32_bf16 v207, s100, v77
    v_dot2c_f32_bf16 v207, s100, v78
    v_dot2c_f32_bf16 v207, s100, v79
    v_dot2c_f32_bf16 v208, v64, v64
    v_dot2c_f32_bf16 v208, v65, v65
    v_dot2c_f32_bf16 v208, v66, v66
    v_dot2c_f32_bf16 v208, v67, v67
    v_dot2c_f32_bf16 v208, v68, v68
    v_dot2c_f32_bf16 v208, v69, v69
    v_dot2c_f32_bf16 v208, v70, v70
    v_dot2c_f32_bf16 v208, v71, v71
    v_dot2c_f32_bf16 v208, v72, v72
    v_dot2c_f32_bf16 v208, v73, v73
    v_dot2c_f32_bf16 v208, v74, v74
    v_dot2c_f32_bf16 v208, v75, v75
    v_dot2c_f32_bf16 v208, v76, v76
    v_dot2c_f32_bf16 v208, v77, v77
    v_dot2c_f32_bf16 v208, v78, v78
    v_dot2c_f32_bf16 v208, v79, v79
    v_add_u32 v200, 65536, v200
    v_add_u32 v201, 65536, v201
    v_add_u32 v202, 65536, v202
    v_add_u32 v203, 65536, v203
    s_waitcnt vmcnt(12)
    ds_read_b128 v[96:99], v200 offset:0
    ds_read_b128 v[100:103], v201 offset:0
    ds_read_b128 v[104:107], v202 offset:0
    ds_read_b128 v[108:111], v203 offset:0
    s_waitcnt lgkmcnt(4)
    v_dot2c_f32_bf16 v207, s100, v80
    v_dot2c_f32_bf16 v207, s100, v81
    v_dot2c_f32_bf16 v207, s100, v82
    v_dot2c_f32_bf16 v207, s100, v83
    v_dot2c_f32_bf16 v207, s100, v84
    v_dot2c_f32_bf16 v207, s100, v85
    v_dot2c_f32_bf16 v207, s100, v86
    v_dot2c_f32_bf16 v207, s100, v87
    v_dot2c_f32_bf16 v207, s100, v88
    v_dot2c_f32_bf16 v207, s100, v89
    v_dot2c_f32_bf16 v207, s100, v90
    v_dot2c_f32_bf16 v207, s100, v91
    v_dot2c_f32_bf16 v207, s100, v92
    v_dot2c_f32_bf16 v207, s100, v93
    v_dot2c_f32_bf16 v207, s100, v94
    v_dot2c_f32_bf16 v207, s100, v95
    v_dot2c_f32_bf16 v208, v80, v80
    v_dot2c_f32_bf16 v208, v81, v81
    v_dot2c_f32_bf16 v208, v82, v82
    v_dot2c_f32_bf16 v208, v83, v83
    v_dot2c_f32_bf16 v208, v84, v84
    v_dot2c_f32_bf16 v208, v85, v85
    v_dot2c_f32_bf16 v208, v86, v86
    v_dot2c_f32_bf16 v208, v87, v87
    v_dot2c_f32_bf16 v208, v88, v88
    v_dot2c_f32_bf16 v208, v89, v89
    v_dot2c_f32_bf16 v208, v90, v90
    v_dot2c_f32_bf16 v208, v91, v91
    v_dot2c_f32_bf16 v208, v92, v92
    v_dot2c_f32_bf16 v208, v93, v93
    v_dot2c_f32_bf16 v208, v94, v94
    v_dot2c_f32_bf16 v208, v95, v95
    s_waitcnt lgkmcnt(0)
    v_dot2c_f32_bf16 v207, s100, v96
    v_dot2c_f32_bf16 v207, s100, v97
    v_dot2c_f32_bf16 v207, s100, v98
    v_dot2c_f32_bf16 v207, s100, v99
    v_dot2c_f32_bf16 v207, s100, v100
    v_dot2c_f32_bf16 v207, s100, v101
    v_dot2c_f32_bf16 v207, s100, v102
    v_dot2c_f32_bf16 v207, s100, v103
    v_dot2c_f32_bf16 v207, s100, v104
    v_dot2c_f32_bf16 v207, s100, v105
    v_dot2c_f32_bf16 v207, s100, v106
    v_dot2c_f32_bf16 v207, s100, v107
    v_dot2c_f32_bf16 v207, s100, v108
    v_dot2c_f32_bf16 v207, s100, v109
    v_dot2c_f32_bf16 v207, s100, v110
    v_dot2c_f32_bf16 v207, s100, v111
    s_waitcnt vmcnt(8)
    ds_read_b128 v[112:115], v200 offset:4096
    ds_read_b128 v[116:119], v201 offset:4096
    ds_read_b128 v[120:123], v202 offset:4096
    ds_read_b128 v[124:127], v203 offset:4096
    v_dot2c_f32_bf16 v208, v96, v96
    v_dot2c_f32_bf16 v208, v97, v97
    v_dot2c_f32_bf16 v208, v98, v98
    v_dot2c_f32_bf16 v208, v99, v99
    v_dot2c_f32_bf16 v208, v100, v100
    v_dot2c_f32_bf16 v208, v101, v101
    v_dot2c_f32_bf16 v208, v102, v102
    v_dot2c_f32_bf16 v208, v103, v103
    v_dot2c_f32_bf16 v208, v104, v104
    v_dot2c_f32_bf16 v208, v105, v105
    v_dot2c_f32_bf16 v208, v106, v106
    v_dot2c_f32_bf16 v208, v107, v107
    v_dot2c_f32_bf16 v208, v108, v108
    v_dot2c_f32_bf16 v208, v109, v109
    v_dot2c_f32_bf16 v208, v110, v110
    v_dot2c_f32_bf16 v208, v111, v111
    s_waitcnt lgkmcnt(0)
    v_dot2c_f32_bf16 v207, s100, v112
    v_dot2c_f32_bf16 v207, s100, v113
    v_dot2c_f32_bf16 v207, s100, v114
    v_dot2c_f32_bf16 v207, s100, v115
    v_dot2c_f32_bf16 v207, s100, v116
    v_dot2c_f32_bf16 v207, s100, v117
    v_dot2c_f32_bf16 v207, s100, v118
    v_dot2c_f32_bf16 v207, s100, v119
    v_dot2c_f32_bf16 v207, s100, v120
    v_dot2c_f32_bf16 v207, s100, v121
    v_dot2c_f32_bf16 v207, s100, v122
    v_dot2c_f32_bf16 v207, s100, v123
    v_dot2c_f32_bf16 v207, s100, v124
    v_dot2c_f32_bf16 v207, s100, v125
    v_dot2c_f32_bf16 v207, s100, v126
    v_dot2c_f32_bf16 v207, s100, v127
    v_dot2c_f32_bf16 v208, v112, v112
    v_dot2c_f32_bf16 v208, v113, v113
    v_dot2c_f32_bf16 v208, v114, v114
    v_mov_b32 v243, v207
    v_dot2c_f32_bf16 v208, v115, v115
    v_dot2c_f32_bf16 v208, v116, v116
    v_permlane32_swap_b32 v243, v207
    v_add_f32 v207, v243, v207
    v_mul_f32 v160, 0xbb000000, v207
    v_mul_f32 v161, 0xbb000000, v207
    v_mul_f32 v162, 0xbb000000, v207
    v_mul_f32 v163, 0xbb000000, v207
    v_dot2c_f32_bf16 v208, v117, v117
    v_dot2c_f32_bf16 v208, v118, v118
    v_dot2c_f32_bf16 v208, v119, v119
    v_dot2c_f32_bf16 v208, v120, v120
    v_dot2c_f32_bf16 v208, v121, v121
    v_dot2c_f32_bf16 v208, v122, v122
    v_dot2c_f32_bf16 v208, v123, v123
    v_dot2c_f32_bf16 v208, v124, v124
    v_dot2c_f32_bf16 v208, v125, v125
    v_dot2c_f32_bf16 v208, v126, v126
    v_dot2c_f32_bf16 v208, v127, v127
    s_add_u32 s39, s3, 65536
    v_mfma_f32_4x4x4_16b_bf16 v[176:179], v[164:165], v[0:1], v[160:163]
    v_mfma_f32_4x4x4_16b_bf16 v[180:183], v[164:165], v[2:3], v[160:163]
    v_mfma_f32_4x4x4_16b_bf16 v[184:187], v[164:165], v[4:5], v[160:163]
    v_mfma_f32_4x4x4_16b_bf16 v[188:191], v[164:165], v[6:7], v[160:163]
    s_add_u32 m0, s3, 32768
    s_add_u32 s94, s28, 0
    buffer_load_dwordx4 v196, s[52:55], s94 offen offset:0 lds
    buffer_load_dwordx4 v197, s[52:55], s94 offen offset:1024 lds
    buffer_load_dwordx4 v198, s[52:55], s94 offen offset:2048 lds
    buffer_load_dwordx4 v199, s[52:55], s94 offen offset:3072 lds
    v_cvt_pk_bf16_f32 v0, v176, v177
    v_cvt_pk_bf16_f32 v1, v178, v179
    v_cvt_pk_bf16_f32 v2, v180, v181
    v_cvt_pk_bf16_f32 v3, v182, v183
    v_cvt_pk_bf16_f32 v4, v184, v185
    v_cvt_pk_bf16_f32 v5, v186, v187
    v_cvt_pk_bf16_f32 v6, v188, v189
    v_cvt_pk_bf16_f32 v7, v190, v191
    v_mfma_f32_4x4x4_16b_bf16 v[176:179], v[164:165], v[8:9], v[160:163]
    v_mfma_f32_4x4x4_16b_bf16 v[180:183], v[164:165], v[10:11], v[160:163]
    v_mfma_f32_4x4x4_16b_bf16 v[184:187], v[164:165], v[12:13], v[160:163]
    v_mfma_f32_4x4x4_16b_bf16 v[188:191], v[164:165], v[14:15], v[160:163]
    s_add_u32 m0, s3, 36864
    s_add_u32 s94, s28, 114688
    buffer_load_dwordx4 v196, s[52:55], s94 offen offset:0 lds
    buffer_load_dwordx4 v197, s[52:55], s94 offen offset:1024 lds
    buffer_load_dwordx4 v198, s[52:55], s94 offen offset:2048 lds
    buffer_load_dwordx4 v199, s[52:55], s94 offen offset:3072 lds
    s_waitcnt vmcnt(8)
    s_barrier
    ds_read_b64_tr_b16 a[192:193], v204 offset:0
    ds_read_b64_tr_b16 a[194:195], v204 offset:512
    ds_read_b64_tr_b16 a[196:197], v205 offset:0
    ds_read_b64_tr_b16 a[198:199], v205 offset:512
    ds_read_b64_tr_b16 a[200:201], v204 offset:2048
    ds_read_b64_tr_b16 a[202:203], v204 offset:2560
    ds_read_b64_tr_b16 a[204:205], v205 offset:2048
    ds_read_b64_tr_b16 a[206:207], v205 offset:2560
    v_cvt_pk_bf16_f32 v8, v176, v177
    v_cvt_pk_bf16_f32 v9, v178, v179
    v_cvt_pk_bf16_f32 v10, v180, v181
    v_cvt_pk_bf16_f32 v11, v182, v183
    v_cvt_pk_bf16_f32 v12, v184, v185
    v_cvt_pk_bf16_f32 v13, v186, v187
    v_cvt_pk_bf16_f32 v14, v188, v189
    v_cvt_pk_bf16_f32 v15, v190, v191
    ds_read_b64_tr_b16 a[208:209], v204 offset:4096
    ds_read_b64_tr_b16 a[210:211], v204 offset:4608
    ds_read_b64_tr_b16 a[212:213], v205 offset:4096
    ds_read_b64_tr_b16 a[214:215], v205 offset:4608
    ds_read_b64_tr_b16 a[216:217], v204 offset:6144
    ds_read_b64_tr_b16 a[218:219], v204 offset:6656
    ds_read_b64_tr_b16 a[220:221], v205 offset:6144
    ds_read_b64_tr_b16 a[222:223], v205 offset:6656
    v_mfma_f32_4x4x4_16b_bf16 v[176:179], v[164:165], v[16:17], v[160:163]
    v_mfma_f32_4x4x4_16b_bf16 v[180:183], v[164:165], v[18:19], v[160:163]
    v_mfma_f32_4x4x4_16b_bf16 v[184:187], v[164:165], v[20:21], v[160:163]
    v_mfma_f32_4x4x4_16b_bf16 v[188:191], v[164:165], v[22:23], v[160:163]
    s_waitcnt lgkmcnt(8)
    v_mfma_f32_32x32x16_bf16 v[128:143], a[192:195], v[0:3], 0
    ds_read_b64_tr_b16 a[224:225], v204 offset:8192
    ds_read_b64_tr_b16 a[226:227], v204 offset:8704
    v_cvt_pk_bf16_f32 v16, v176, v177
    v_cvt_pk_bf16_f32 v17, v178, v179
    v_mfma_f32_32x32x16_bf16 v[144:159], a[196:199], v[0:3], 0
    ds_read_b64_tr_b16 a[228:229], v205 offset:8192
    ds_read_b64_tr_b16 a[230:231], v205 offset:8704
    s_add_u32 m0, s3, 131072
    s_nop 0
    buffer_load_dwordx4 v192, s[56:59], s0 offen offset:0 lds
    v_cvt_pk_bf16_f32 v18, v180, v181
    v_cvt_pk_bf16_f32 v19, v182, v183
    v_mfma_f32_32x32x16_bf16 v[128:143], a[200:203], v[4:7], v[128:143]
    ds_read_b64_tr_b16 a[232:233], v204 offset:10240
    ds_read_b64_tr_b16 a[234:235], v204 offset:10752
    buffer_load_dwordx4 v193, s[56:59], s0 offen offset:1024 lds
    v_cvt_pk_bf16_f32 v20, v184, v185
    v_cvt_pk_bf16_f32 v21, v186, v187
    v_mfma_f32_32x32x16_bf16 v[144:159], a[204:207], v[4:7], v[144:159]
    s_waitcnt lgkmcnt(6)
    ds_read_b64_tr_b16 a[236:237], v205 offset:10240
    ds_read_b64_tr_b16 a[238:239], v205 offset:10752
    v_cvt_pk_bf16_f32 v22, v188, v189
    v_cvt_pk_bf16_f32 v23, v190, v191
    v_subrev_u32 v200, s39, v200
    v_subrev_u32 v201, s39, v201
    v_subrev_u32 v202, s39, v202
    v_mfma_f32_4x4x4_16b_bf16 v[176:179], v[164:165], v[24:25], v[160:163]
    v_mfma_f32_4x4x4_16b_bf16 v[180:183], v[164:165], v[26:27], v[160:163]
    v_mfma_f32_4x4x4_16b_bf16 v[184:187], v[164:165], v[28:29], v[160:163]
    v_mfma_f32_4x4x4_16b_bf16 v[188:191], v[164:165], v[30:31], v[160:163]
    v_mfma_f32_32x32x16_bf16 v[128:143], a[208:211], v[8:11], v[128:143]
    ds_read_b64_tr_b16 a[240:241], v204 offset:12288
    ds_read_b64_tr_b16 a[242:243], v204 offset:12800
    buffer_load_dwordx4 v194, s[56:59], s0 offen offset:2048 lds
    v_cvt_pk_bf16_f32 v24, v176, v177
    v_cvt_pk_bf16_f32 v25, v178, v179
    v_mfma_f32_32x32x16_bf16 v[144:159], a[212:215], v[8:11], v[144:159]
    ds_read_b64_tr_b16 a[244:245], v205 offset:12288
    ds_read_b64_tr_b16 a[246:247], v205 offset:12800
    buffer_load_dwordx4 v195, s[56:59], s0 offen offset:3072 lds
    v_cvt_pk_bf16_f32 v26, v180, v181
    v_cvt_pk_bf16_f32 v27, v182, v183
    v_mfma_f32_32x32x16_bf16 v[128:143], a[216:219], v[12:15], v[128:143]
    ds_read_b64_tr_b16 a[248:249], v204 offset:14336
    ds_read_b64_tr_b16 a[250:251], v204 offset:14848
    v_cvt_pk_bf16_f32 v28, v184, v185
    v_cvt_pk_bf16_f32 v29, v186, v187
    v_subrev_u32 v203, s39, v203
    v_mov_b32 v168, v208
    v_mul_f32 v207, 0x3b000000, v207
    v_mfma_f32_32x32x16_bf16 v[144:159], a[220:223], v[12:15], v[144:159]
    s_waitcnt lgkmcnt(6)
    ds_read_b64_tr_b16 a[252:253], v205 offset:14336
    ds_read_b64_tr_b16 a[254:255], v205 offset:14848
    v_cvt_pk_bf16_f32 v30, v188, v189
    v_cvt_pk_bf16_f32 v31, v190, v191
    v_permlane32_swap_b32 v168, v208
    v_add_f32 v208, v168, v208
    v_mul_f32 v168, 0x3b000000, v208
    v_mfma_f32_4x4x4_16b_bf16 v[176:179], v[164:165], v[32:33], v[160:163]
    v_mfma_f32_4x4x4_16b_bf16 v[180:183], v[164:165], v[34:35], v[160:163]
    v_mfma_f32_4x4x4_16b_bf16 v[184:187], v[164:165], v[36:37], v[160:163]
    v_mfma_f32_4x4x4_16b_bf16 v[188:191], v[164:165], v[38:39], v[160:163]
    v_mfma_f32_32x32x16_bf16 v[128:143], a[224:227], v[16:19], v[128:143]
    ds_read_b64_tr_b16 a[192:193], v204 offset:16384
    ds_read_b64_tr_b16 a[194:195], v204 offset:16896
    s_add_u32 m0, s3, 65536
    s_xor_b32 s94, s26, 0
    buffer_load_dwordx4 v192, s[44:47], s94 offen offset:0 lds
    v_cvt_pk_bf16_f32 v32, v176, v177
    v_cvt_pk_bf16_f32 v33, v178, v179
    v_mfma_f32_32x32x16_bf16 v[144:159], a[228:231], v[16:19], v[144:159]
    ds_read_b64_tr_b16 a[196:197], v205 offset:16384
    ds_read_b64_tr_b16 a[198:199], v205 offset:16896
    buffer_load_dwordx4 v193, s[44:47], s94 offen offset:1024 lds
    v_cvt_pk_bf16_f32 v34, v180, v181
    v_cvt_pk_bf16_f32 v35, v182, v183
    v_mfma_f32_32x32x16_bf16 v[128:143], a[232:235], v[20:23], v[128:143]
    ds_read_b64_tr_b16 a[200:201], v204 offset:18432
    ds_read_b64_tr_b16 a[202:203], v204 offset:18944
    v_cvt_pk_bf16_f32 v36, v184, v185
    v_cvt_pk_bf16_f32 v37, v186, v187
    v_fma_f32 v168, -v207, v207, v168
    v_max_f32 v168, 0, v168
    v_mfma_f32_32x32x16_bf16 v[144:159], a[236:239], v[20:23], v[144:159]
    s_waitcnt lgkmcnt(6)
    ds_read_b64_tr_b16 a[204:205], v205 offset:18432
    ds_read_b64_tr_b16 a[206:207], v205 offset:18944
    buffer_load_dwordx4 v194, s[44:47], s94 offen offset:2048 lds
    v_cvt_pk_bf16_f32 v38, v188, v189
    v_cvt_pk_bf16_f32 v39, v190, v191
    v_mfma_f32_4x4x4_16b_bf16 v[176:179], v[164:165], v[40:41], v[160:163]
    v_mfma_f32_4x4x4_16b_bf16 v[180:183], v[164:165], v[42:43], v[160:163]
    v_mfma_f32_4x4x4_16b_bf16 v[184:187], v[164:165], v[44:45], v[160:163]
    v_mfma_f32_4x4x4_16b_bf16 v[188:191], v[164:165], v[46:47], v[160:163]
    v_mfma_f32_32x32x16_bf16 v[128:143], a[240:243], v[24:27], v[128:143]
    ds_read_b64_tr_b16 a[208:209], v204 offset:20480
    ds_read_b64_tr_b16 a[210:211], v204 offset:20992
    v_cvt_pk_bf16_f32 v40, v176, v177
    v_cvt_pk_bf16_f32 v41, v178, v179
    v_add_f32 v169, 0x3727c5ac, v168
    v_cvt_pk_bf16_f32 v170, v168, v168
    v_mfma_f32_32x32x16_bf16 v[144:159], a[244:247], v[24:27], v[144:159]
    ds_read_b64_tr_b16 a[212:213], v205 offset:20480
    ds_read_b64_tr_b16 a[214:215], v205 offset:20992
    buffer_load_dwordx4 v195, s[44:47], s94 offen offset:3072 lds
    v_cvt_pk_bf16_f32 v42, v180, v181
    v_cvt_pk_bf16_f32 v43, v182, v183
    v_lshlrev_b32 v170, 16, v170
    v_mfma_f32_32x32x16_bf16 v[128:143], a[248:251], v[28:31], v[128:143]
    ds_read_b64_tr_b16 a[216:217], v204 offset:22528
    ds_read_b64_tr_b16 a[218:219], v204 offset:23040
    v_cvt_pk_bf16_f32 v44, v184, v185
    v_cvt_pk_bf16_f32 v45, v186, v187
    v_add_f32 v170, 0x3727c5ac, v170
    v_cvt_pk_bf16_f32 v170, v170, v170
    v_lshlrev_b32 v170, 16, v170
    v_mfma_f32_32x32x16_bf16 v[144:159], a[252:255], v[28:31], v[144:159]
    s_waitcnt lgkmcnt(6)
    ds_read_b64_tr_b16 a[220:221], v205 offset:22528
    ds_read_b64_tr_b16 a[222:223], v205 offset:23040
    s_add_u32 m0, s3, 69632
    s_xor_b32 s94, s26, 0
    buffer_load_dwordx4 v192, s[48:51], s94 offen offset:0 lds
    v_cvt_pk_bf16_f32 v46, v188, v189
    v_cvt_pk_bf16_f32 v47, v190, v191
    v_mfma_f32_4x4x4_16b_bf16 v[176:179], v[164:165], v[48:49], v[160:163]
    v_mfma_f32_4x4x4_16b_bf16 v[180:183], v[164:165], v[50:51], v[160:163]
    v_mfma_f32_4x4x4_16b_bf16 v[184:187], v[164:165], v[52:53], v[160:163]
    v_mfma_f32_4x4x4_16b_bf16 v[188:191], v[164:165], v[54:55], v[160:163]
    v_mfma_f32_32x32x16_bf16 v[128:143], a[192:195], v[32:35], v[128:143]
    ds_read_b64_tr_b16 a[224:225], v204 offset:24576
    ds_read_b64_tr_b16 a[226:227], v204 offset:25088
    v_cvt_pk_bf16_f32 v48, v176, v177
    v_cvt_pk_bf16_f32 v49, v178, v179
    v_mfma_f32_32x32x16_bf16 v[144:159], a[196:199], v[32:35], v[144:159]
    ds_read_b64_tr_b16 a[228:229], v205 offset:24576
    ds_read_b64_tr_b16 a[230:231], v205 offset:25088
    buffer_load_dwordx4 v193, s[48:51], s94 offen offset:1024 lds
    v_cvt_pk_bf16_f32 v50, v180, v181
    v_cvt_pk_bf16_f32 v51, v182, v183
    v_mfma_f32_32x32x16_bf16 v[128:143], a[200:203], v[36:39], v[128:143]
    ds_read_b64_tr_b16 a[232:233], v204 offset:26624
    ds_read_b64_tr_b16 a[234:235], v204 offset:27136
    v_cvt_pk_bf16_f32 v52, v184, v185
    v_cvt_pk_bf16_f32 v53, v186, v187
    v_sqrt_f32 v170, v170
    v_fmac_f32 v168, 0x3727c5ac, v169
    v_cvt_pk_bf16_f32 v170, v170, v170
    v_mfma_f32_32x32x16_bf16 v[144:159], a[204:207], v[36:39], v[144:159]
    s_waitcnt lgkmcnt(6)
    ds_read_b64_tr_b16 a[236:237], v205 offset:26624
    ds_read_b64_tr_b16 a[238:239], v205 offset:27136
    buffer_load_dwordx4 v194, s[48:51], s94 offen offset:2048 lds
    v_cvt_pk_bf16_f32 v54, v188, v189
    v_cvt_pk_bf16_f32 v55, v190, v191
    v_mfma_f32_4x4x4_16b_bf16 v[176:179], v[164:165], v[56:57], v[160:163]
    v_mfma_f32_4x4x4_16b_bf16 v[180:183], v[164:165], v[58:59], v[160:163]
    v_mfma_f32_4x4x4_16b_bf16 v[184:187], v[164:165], v[60:61], v[160:163]
    v_mfma_f32_4x4x4_16b_bf16 v[188:191], v[164:165], v[62:63], v[160:163]
    v_mfma_f32_32x32x16_bf16 v[128:143], a[208:211], v[40:43], v[128:143]
    ds_read_b64_tr_b16 a[240:241], v204 offset:28672
    ds_read_b64_tr_b16 a[242:243], v204 offset:29184
    v_cvt_pk_bf16_f32 v56, v176, v177
    v_cvt_pk_bf16_f32 v57, v178, v179
    v_lshlrev_b32 v170, 16, v170
    v_rcp_f32 v208, v170
    v_mfma_f32_32x32x16_bf16 v[144:159], a[212:215], v[40:43], v[144:159]
    ds_read_b64_tr_b16 a[244:245], v205 offset:28672
    ds_read_b64_tr_b16 a[246:247], v205 offset:29184
    buffer_load_dword v251, v250, s[80:83], 0 offen sc1
    buffer_load_dwordx4 v195, s[48:51], s94 offen offset:3072 lds
    v_cvt_pk_bf16_f32 v58, v180, v181
    v_cvt_pk_bf16_f32 v59, v182, v183
    v_mfma_f32_32x32x16_bf16 v[128:143], a[216:219], v[44:47], v[128:143]
    ds_read_b64_tr_b16 a[248:249], v204 offset:30720
    ds_read_b64_tr_b16 a[250:251], v204 offset:31232
    v_cvt_pk_bf16_f32 v60, v184, v185
    v_cvt_pk_bf16_f32 v61, v186, v187
    v_mfma_f32_32x32x16_bf16 v[144:159], a[220:223], v[44:47], v[144:159]
    s_waitcnt lgkmcnt(6)
    ds_read_b64_tr_b16 a[252:253], v205 offset:30720
    ds_read_b64_tr_b16 a[254:255], v205 offset:31232
    v_cvt_pk_bf16_f32 v62, v188, v189
    v_cvt_pk_bf16_f32 v63, v190, v191
    v_rsq_f32 v170, v168
    v_mfma_f32_4x4x4_16b_bf16 v[176:179], v[164:165], v[64:65], v[160:163]
    v_mfma_f32_4x4x4_16b_bf16 v[180:183], v[164:165], v[66:67], v[160:163]
    v_mfma_f32_4x4x4_16b_bf16 v[184:187], v[164:165], v[68:69], v[160:163]
    v_mfma_f32_4x4x4_16b_bf16 v[188:191], v[164:165], v[70:71], v[160:163]
    s_waitcnt vmcnt(13)
    s_barrier
    v_mfma_f32_32x32x16_bf16 v[128:143], a[224:227], v[48:51], v[128:143]
    ds_read_b64_tr_b16 a[192:193], v204 offset:32768
    ds_read_b64_tr_b16 a[194:195], v204 offset:33280
    s_add_u32 m0, s3, 98304
    s_xor_b32 s94, s26, 512
    buffer_load_dwordx4 v192, s[44:47], s94 offen offset:0 lds
    v_cvt_pk_bf16_f32 v64, v176, v177
    v_cvt_pk_bf16_f32 v65, v178, v179
    v_mfma_f32_32x32x16_bf16 v[144:159], a[228:231], v[48:51], v[144:159]
    ds_read_b64_tr_b16 a[196:197], v205 offset:32768
    ds_read_b64_tr_b16 a[198:199], v205 offset:33280
    buffer_load_dwordx4 v193, s[44:47], s94 offen offset:1024 lds
    v_cvt_pk_bf16_f32 v66, v180, v181
    v_cvt_pk_bf16_f32 v67, v182, v183
    v_mfma_f32_32x32x16_bf16 v[128:143], a[232:235], v[52:55], v[128:143]
    ds_read_b64_tr_b16 a[200:201], v204 offset:34816
    ds_read_b64_tr_b16 a[202:203], v204 offset:35328
    v_cvt_pk_bf16_f32 v68, v184, v185
    v_cvt_pk_bf16_f32 v69, v186, v187
    v_mfma_f32_32x32x16_bf16 v[144:159], a[236:239], v[52:55], v[144:159]
    s_waitcnt lgkmcnt(6)
    ds_read_b64_tr_b16 a[204:205], v205 offset:34816
    ds_read_b64_tr_b16 a[206:207], v205 offset:35328
    buffer_load_dwordx4 v194, s[44:47], s94 offen offset:2048 lds
    v_cvt_pk_bf16_f32 v70, v188, v189
    v_cvt_pk_bf16_f32 v71, v190, v191
    v_mfma_f32_4x4x4_16b_bf16 v[176:179], v[164:165], v[72:73], v[160:163]
    v_mfma_f32_4x4x4_16b_bf16 v[180:183], v[164:165], v[74:75], v[160:163]
    v_mfma_f32_4x4x4_16b_bf16 v[184:187], v[164:165], v[76:77], v[160:163]
    v_mfma_f32_4x4x4_16b_bf16 v[188:191], v[164:165], v[78:79], v[160:163]
    v_mfma_f32_32x32x16_bf16 v[128:143], a[240:243], v[56:59], v[128:143]
    ds_read_b64_tr_b16 a[208:209], v204 offset:36864
    ds_read_b64_tr_b16 a[210:211], v204 offset:37376
    v_cvt_pk_bf16_f32 v72, v176, v177
    v_cvt_pk_bf16_f32 v73, v178, v179
    v_sqrt_f32 v209, v168
    v_mul_f32 v210, 0xc0135761, v170
    v_mfma_f32_32x32x16_bf16 v[144:159], a[244:247], v[56:59], v[144:159]
    ds_read_b64_tr_b16 a[212:213], v205 offset:36864
    ds_read_b64_tr_b16 a[214:215], v205 offset:37376
    buffer_load_dwordx4 v195, s[44:47], s94 offen offset:3072 lds
    v_cvt_pk_bf16_f32 v74, v180, v181
    v_cvt_pk_bf16_f32 v75, v182, v183
    v_mfma_f32_32x32x16_bf16 v[128:143], a[248:251], v[60:63], v[128:143]
    ds_read_b64_tr_b16 a[216:217], v204 offset:38912
    ds_read_b64_tr_b16 a[218:219], v204 offset:39424
    v_cvt_pk_bf16_f32 v76, v184, v185
    v_cvt_pk_bf16_f32 v77, v186, v187
    v_mul_f32 v171, v170, v170
    v_mul_f32 v171, 0x3d372713, v171
    v_mul_f32 v211, v210, v171
    v_mfma_f32_32x32x16_bf16 v[144:159], a[252:255], v[60:63], v[144:159]
    s_waitcnt lgkmcnt(6)
    ds_read_b64_tr_b16 a[220:221], v205 offset:38912
    ds_read_b64_tr_b16 a[222:223], v205 offset:39424
    s_add_u32 m0, s3, 102400
    s_xor_b32 s94, s26, 512
    buffer_load_dwordx4 v192, s[48:51], s94 offen offset:0 lds
    v_cvt_pk_bf16_f32 v78, v188, v189
    v_cvt_pk_bf16_f32 v79, v190, v191
    v_mfma_f32_4x4x4_16b_bf16 v[176:179], v[164:165], v[80:81], v[160:163]
    v_mfma_f32_4x4x4_16b_bf16 v[180:183], v[164:165], v[82:83], v[160:163]
    v_mfma_f32_4x4x4_16b_bf16 v[184:187], v[164:165], v[84:85], v[160:163]
    v_mfma_f32_4x4x4_16b_bf16 v[188:191], v[164:165], v[86:87], v[160:163]
    v_mfma_f32_32x32x16_bf16 v[128:143], a[192:195], v[64:67], v[128:143]
    ds_read_b64_tr_b16 a[224:225], v204 offset:40960
    ds_read_b64_tr_b16 a[226:227], v204 offset:41472
    v_cvt_pk_bf16_f32 v80, v176, v177
    v_cvt_pk_bf16_f32 v81, v178, v179
    v_cvt_pk_bf16_f32 v170, v209, v209
    v_mfma_f32_32x32x16_bf16 v[144:159], a[196:199], v[64:67], v[144:159]
    ds_read_b64_tr_b16 a[228:229], v205 offset:40960
    ds_read_b64_tr_b16 a[230:231], v205 offset:41472
    buffer_load_dwordx4 v193, s[48:51], s94 offen offset:1024 lds
    v_cvt_pk_bf16_f32 v82, v180, v181
    v_cvt_pk_bf16_f32 v83, v182, v183
    v_mfma_f32_32x32x16_bf16 v[128:143], a[200:203], v[68:71], v[128:143]
    ds_read_b64_tr_b16 a[232:233], v204 offset:43008
    ds_read_b64_tr_b16 a[234:235], v204 offset:43520
    s_waitcnt vmcnt(15)
    s_cmp_ge_u32 s88, 2
    s_cbranch_scc1 L_rp2
    ds_read_b64_tr_b16 a[0:1], v252 offset:0
    ds_read_b64_tr_b16 a[2:3], v254 offset:1024
    ds_read_b64_tr_b16 a[4:5], v253 offset:512
    ds_read_b64_tr_b16 a[6:7], v255 offset:1536
    ds_read_b64_tr_b16 a[8:9], v254 offset:0
    ds_read_b64_tr_b16 a[10:11], v252 offset:1024
    ds_read_b64_tr_b16 a[12:13], v255 offset:512
    ds_read_b64_tr_b16 a[14:15], v253 offset:1536
    s_branch L_rpjoin
L_rp2:
    ds_read_b128 a[0:3], v252
    ds_read_b128 a[4:7], v253
    ds_read_b128 a[8:11], v254
    ds_read_b128 a[12:15], v255
L_rpjoin:
    v_cvt_pk_bf16_f32 v84, v184, v185
    v_cvt_pk_bf16_f32 v85, v186, v187
    v_and_b32 v171, 0xffff0000, v170
    v_sub_f32 v171, v209, v171
    v_cvt_pk_bf16_f32 v170, v209, v171
    v_mfma_f32_32x32x16_bf16 v[144:159], a[204:207], v[68:71], v[144:159]
    s_waitcnt lgkmcnt(6)
    ds_read_b64_tr_b16 a[236:237], v205 offset:43008
    ds_read_b64_tr_b16 a[238:239], v205 offset:43520
    buffer_load_dwordx4 v194, s[48:51], s94 offen offset:2048 lds
    v_cvt_pk_bf16_f32 v86, v188, v189
    v_cvt_pk_bf16_f32 v87, v190, v191
    v_mfma_f32_4x4x4_16b_bf16 v[176:179], v[164:165], v[88:89], v[160:163]
    v_mfma_f32_4x4x4_16b_bf16 v[180:183], v[164:165], v[90:91], v[160:163]
    v_mfma_f32_4x4x4_16b_bf16 v[184:187], v[164:165], v[92:93], v[160:163]
    v_mfma_f32_4x4x4_16b_bf16 v[188:191], v[164:165], v[94:95], v[160:163]
    v_mfma_f32_32x32x16_bf16 v[128:143], a[208:211], v[72:75], v[128:143]
    ds_read_b64_tr_b16 a[240:241], v204 offset:45056
    ds_read_b64_tr_b16 a[242:243], v204 offset:45568
    s_waitcnt lgkmcnt(4)
    buffer_store_dwordx4 a[0:3], v206, s[72:75], s97 offen offset:0 sc1
    v_cvt_pk_bf16_f32 v88, v176, v177
    v_cvt_pk_bf16_f32 v89, v178, v179
    v_mfma_f32_32x32x16_bf16 v[144:159], a[212:215], v[72:75], v[144:159]
    ds_read_b64_tr_b16 a[244:245], v205 offset:45056
    ds_read_b64_tr_b16 a[246:247], v205 offset:45568
    buffer_load_dwordx4 v195, s[48:51], s94 offen offset:3072 lds
    v_cvt_pk_bf16_f32 v90, v180, v181
    v_cvt_pk_bf16_f32 v91, v182, v183
    v_mfma_f32_32x32x16_bf16 v[128:143], a[216:219], v[76:79], v[128:143]
    ds_read_b64_tr_b16 a[248:249], v204 offset:47104
    ds_read_b64_tr_b16 a[250:251], v204 offset:47616
    v_cvt_pk_bf16_f32 v92, v184, v185
    v_cvt_pk_bf16_f32 v93, v186, v187
    v_mfma_f32_32x32x16_bf16 v[144:159], a[220:223], v[76:79], v[144:159]
    s_waitcnt lgkmcnt(6)
    ds_read_b64_tr_b16 a[252:253], v205 offset:47104
    ds_read_b64_tr_b16 a[254:255], v205 offset:47616
    buffer_store_dwordx4 a[4:7], v206, s[72:75], s97 offen offset:1024 sc1
    v_cvt_pk_bf16_f32 v94, v188, v189
    v_cvt_pk_bf16_f32 v95, v190, v191
    v_mfma_f32_4x4x4_16b_bf16 v[176:179], v[164:165], v[96:97], v[160:163]
    v_mfma_f32_4x4x4_16b_bf16 v[180:183], v[164:165], v[98:99], v[160:163]
    v_mfma_f32_4x4x4_16b_bf16 v[184:187], v[164:165], v[100:101], v[160:163]
    v_mfma_f32_4x4x4_16b_bf16 v[188:191], v[164:165], v[102:103], v[160:163]
    v_mfma_f32_32x32x16_bf16 v[128:143], a[224:227], v[80:83], v[128:143]
    ds_read_b64_tr_b16 a[192:193], v204 offset:49152
    ds_read_b64_tr_b16 a[194:195], v204 offset:49664
    v_cvt_pk_bf16_f32 v96, v176, v177
    v_cvt_pk_bf16_f32 v97, v178, v179
    v_mfma_f32_32x32x16_bf16 v[144:159], a[228:231], v[80:83], v[144:159]
    ds_read_b64_tr_b16 a[196:197], v205 offset:49152
    ds_read_b64_tr_b16 a[198:199], v205 offset:49664
    v_cvt_pk_bf16_f32 v98, v180, v181
    v_cvt_pk_bf16_f32 v99, v182, v183
    v_mfma_f32_32x32x16_bf16 v[128:143], a[232:235], v[84:87], v[128:143]
    ds_read_b64_tr_b16 a[200:201], v204 offset:51200
    ds_read_b64_tr_b16 a[202:203], v204 offset:51712
    buffer_store_dwordx4 a[8:11], v206, s[72:75], s98 offen offset:0 sc1
    v_cvt_pk_bf16_f32 v100, v184, v185
    v_cvt_pk_bf16_f32 v101, v186, v187
    v_mfma_f32_32x32x16_bf16 v[144:159], a[236:239], v[84:87], v[144:159]
    s_waitcnt lgkmcnt(6)
    ds_read_b64_tr_b16 a[204:205], v205 offset:51200
    ds_read_b64_tr_b16 a[206:207], v205 offset:51712
    v_cvt_pk_bf16_f32 v102, v188, v189
    v_cvt_pk_bf16_f32 v103, v190, v191
    v_mfma_f32_4x4x4_16b_bf16 v[176:179], v[164:165], v[104:105], v[160:163]
    v_mfma_f32_4x4x4_16b_bf16 v[180:183], v[164:165], v[106:107], v[160:163]
    v_mfma_f32_4x4x4_16b_bf16 v[184:187], v[164:165], v[108:109], v[160:163]
    v_mfma_f32_4x4x4_16b_bf16 v[188:191], v[164:165], v[110:111], v[160:163]
    v_mfma_f32_32x32x16_bf16 v[128:143], a[240:243], v[88:91], v[128:143]
    ds_read_b64_tr_b16 a[208:209], v204 offset:53248
    ds_read_b64_tr_b16 a[210:211], v204 offset:53760
    v_cvt_pk_bf16_f32 v104, v176, v177
    v_cvt_pk_bf16_f32 v105, v178, v179
    v_mul_lo_u32 v234, v170, v248
    v_sub_u32 v230, v170, v234
    v_mfma_f32_32x32x16_bf16 v[144:159], a[244:247], v[88:91], v[144:159]
    ds_read_b64_tr_b16 a[212:213], v205 offset:53248
    ds_read_b64_tr_b16 a[214:215], v205 offset:53760
    buffer_store_dwordx4 a[12:15], v206, s[72:75], s98 offen offset:1024 sc1
    v_cvt_pk_bf16_f32 v106, v180, v181
    v_cvt_pk_bf16_f32 v107, v182, v183
    v_mfma_f32_32x32x16_bf16 v[128:143], a[248:251], v[92:95], v[128:143]
    ds_read_b64_tr_b16 a[216:217], v204 offset:55296
    ds_read_b64_tr_b16 a[218:219], v204 offset:55808
    v_cvt_pk_bf16_f32 v108, v184, v185
    v_cvt_pk_bf16_f32 v109, v186, v187
    v_mfma_f32_32x32x16_bf16 v[144:159], a[252:255], v[92:95], v[144:159]
    s_waitcnt lgkmcnt(6)
    ds_read_b64_tr_b16 a[220:221], v205 offset:55296
    ds_read_b64_tr_b16 a[222:223], v205 offset:55808
    v_cvt_pk_bf16_f32 v110, v188, v189
    v_cvt_pk_bf16_f32 v111, v190, v191
    v_mfma_f32_4x4x4_16b_bf16 v[176:179], v[164:165], v[112:113], v[160:163]
    v_mfma_f32_4x4x4_16b_bf16 v[180:183], v[164:165], v[114:115], v[160:163]
    v_mfma_f32_4x4x4_16b_bf16 v[184:187], v[164:165], v[116:117], v[160:163]
    v_mfma_f32_4x4x4_16b_bf16 v[188:191], v[164:165], v[118:119], v[160:163]
    v_mfma_f32_32x32x16_bf16 v[128:143], a[192:195], v[96:99], v[128:143]
    ds_read_b64_tr_b16 a[224:225], v204 offset:57344
    ds_read_b64_tr_b16 a[226:227], v204 offset:57856
    s_add_u32 m0, s3, 131072
    s_add_u32 s94, s27, 128
    buffer_load_dwordx4 v196, s[68:71], s94 offen offset:0 lds
    v_cvt_pk_bf16_f32 v112, v176, v177
    v_cvt_pk_bf16_f32 v113, v178, v179
    v_mfma_f32_32x32x16_bf16 v[144:159], a[196:199], v[96:99], v[144:159]
    ds_read_b64_tr_b16 a[228:229], v205 offset:57344
    ds_read_b64_tr_b16 a[230:231], v205 offset:57856
    buffer_load_dwordx4 v197, s[68:71], s94 offen offset:1024 lds
    v_cvt_pk_bf16_f32 v114, v180, v181
    v_cvt_pk_bf16_f32 v115, v182, v183
    v_mfma_f32_32x32x16_bf16 v[128:143], a[200:203], v[100:103], v[128:143]
    ds_read_b64_tr_b16 a[232:233], v204 offset:59392
    ds_read_b64_tr_b16 a[234:235], v204 offset:59904
    v_cvt_pk_bf16_f32 v116, v184, v185
    v_cvt_pk_bf16_f32 v117, v186, v187
    v_mfma_f32_32x32x16_bf16 v[144:159], a[204:207], v[100:103], v[144:159]
    s_waitcnt lgkmcnt(6)
    ds_read_b64_tr_b16 a[236:237], v205 offset:59392
    ds_read_b64_tr_b16 a[238:239], v205 offset:59904
    buffer_load_dwordx4 v198, s[68:71], s94 offen offset:2048 lds
    v_cvt_pk_bf16_f32 v118, v188, v189
    v_cvt_pk_bf16_f32 v119, v190, v191
    v_mfma_f32_4x4x4_16b_bf16 v[176:179], v[164:165], v[120:121], v[160:163]
    v_mfma_f32_4x4x4_16b_bf16 v[180:183], v[164:165], v[122:123], v[160:163]
    v_mfma_f32_4x4x4_16b_bf16 v[184:187], v[164:165], v[124:125], v[160:163]
    v_mfma_f32_4x4x4_16b_bf16 v[188:191], v[164:165], v[126:127], v[160:163]
    v_mfma_f32_32x32x16_bf16 v[128:143], a[208:211], v[104:107], v[128:143]
    ds_read_b64_tr_b16 a[240:241], v204 offset:61440
    ds_read_b64_tr_b16 a[242:243], v204 offset:61952
    v_cvt_pk_bf16_f32 v120, v176, v177
    v_cvt_pk_bf16_f32 v121, v178, v179
    v_mfma_f32_32x32x16_bf16 v[144:159], a[212:215], v[104:107], v[144:159]
    ds_read_b64_tr_b16 a[244:245], v205 offset:61440
    ds_read_b64_tr_b16 a[246:247], v205 offset:61952
    buffer_load_dwordx4 v199, s[68:71], s94 offen offset:3072 lds
    v_cvt_pk_bf16_f32 v122, v180, v181
    v_cvt_pk_bf16_f32 v123, v182, v183
    v_mfma_f32_32x32x16_bf16 v[128:143], a[216:219], v[108:111], v[128:143]
    ds_read_b64_tr_b16 a[248:249], v204 offset:63488
    ds_read_b64_tr_b16 a[250:251], v204 offset:64000
    v_cvt_pk_bf16_f32 v124, v184, v185
    v_cvt_pk_bf16_f32 v125, v186, v187
    v_mfma_f32_32x32x16_bf16 v[144:159], a[220:223], v[108:111], v[144:159]
    s_waitcnt lgkmcnt(6)
    ds_read_b64_tr_b16 a[252:253], v205 offset:63488
    ds_read_b64_tr_b16 a[254:255], v205 offset:64000
    s_add_u32 m0, s3, 135168
    s_add_u32 s94, s27, 114816
    buffer_load_dwordx4 v196, s[68:71], s94 offen offset:0 lds
    v_cvt_pk_bf16_f32 v126, v188, v189
    v_cvt_pk_bf16_f32 v127, v190, v191
    s_waitcnt vmcnt(17)
    s_barrier
    v_mfma_f32_32x32x16_bf16 v[128:143], a[224:227], v[112:115], v[128:143]
    ds_read_b128 a[192:195], v200 offset:0
    v_mfma_f32_32x32x16_bf16 v[144:159], a[228:231], v[112:115], v[144:159]
    ds_read_b128 a[196:199], v200 offset:4096
    v_cmp_eq_u32 vcc, 0, v251
    s_mov_b32 s96, 0
    s_nop 0
    s_cmp_eq_u64 vcc, 0
    s_cbranch_scc1 L_go_done
L_go:
    buffer_load_dword v251, v250, s[80:83], 0 offen sc1
    s_waitcnt vmcnt(0)
    v_cmp_eq_u32 vcc, 0, v251
    s_add_u32 s96, s96, 1
    s_cmp_ge_u32 s96, 100000
    s_cbranch_scc1 L_go_done
    s_cmp_eq_u64 vcc, 0
    s_cbranch_scc0 L_go
L_go_done:
    buffer_load_dwordx4 v197, s[68:71], s94 offen offset:1024 lds
    v_mfma_f32_32x32x16_bf16 v[128:143], a[232:235], v[116:119], v[128:143]
    ds_read_b128 a[200:203], v201 offset:0
    v_mfma_f32_32x32x16_bf16 v[144:159], a[236:239], v[116:119], v[144:159]
    s_waitcnt lgkmcnt(3)
    ds_read_b128 a[204:207], v201 offset:4096
    buffer_load_dwordx4 v198, s[68:71], s94 offen offset:2048 lds
    v_mfma_f32_32x32x16_bf16 v[128:143], a[240:243], v[120:123], v[128:143]
    ds_read_b128 a[208:211], v202 offset:0
    v_mfma_f32_32x32x16_bf16 v[144:159], a[244:247], v[120:123], v[144:159]
    ds_read_b128 a[212:215], v202 offset:4096
    buffer_load_dwordx4 v199, s[68:71], s94 offen offset:3072 lds
    v_mfma_f32_32x32x16_bf16 v[128:143], a[248:251], v[124:127], v[128:143]
    v_mfma_f32_32x32x16_bf16 v[128:143], v[226:229], v[230:233], v[128:143]
    ds_read_b128 a[216:219], v203 offset:0
    v_mfma_f32_32x32x16_bf16 v[144:159], a[252:255], v[124:127], v[144:159]
    v_mfma_f32_32x32x16_bf16 v[144:159], v[226:229], v[234:237], v[144:159]
    s_waitcnt lgkmcnt(3)
    ds_read_b128 a[220:223], v203 offset:4096
    v_mfma_f32_32x32x16_bf16 v[160:175], v[0:3], a[192:195], 0
    ds_read_b128 a[224:227], v200 offset:8192
    v_mfma_f32_32x32x16_bf16 v[176:191], v[0:3], a[196:199], 0
    ds_read_b128 a[228:231], v200 offset:12288
    s_nop 2
    v_mul_f32 v252, v128, v128
    v_mul_f32 v253, v129, v129
    v_mul_f32 v254, v130, v130
    v_mul_f32 v255, v131, v131
    v_fma_f32 v252, v252, v211, v210
    v_fma_f32 v253, v253, v211, v210
    v_mfma_f32_32x32x16_bf16 v[160:175], v[4:7], a[200:203], v[160:175]
    ds_read_b128 a[232:235], v201 offset:8192
    s_waitcnt vmcnt(8)
    buffer_store_dword v240, v238, s[72:75], s101 offen sc1
    v_fma_f32 v254, v254, v211, v210
    v_fma_f32 v255, v255, v211, v210
    v_mfma_f32_32x32x16_bf16 v[176:191], v[4:7], a[204:207], v[176:191]
    s_waitcnt lgkmcnt(3)
    ds_read_b128 a[236:239], v201 offset:12288
    v_mul_f32 v252, v252, v128
    v_mul_f32 v253, v253, v129
    v_mul_f32 v254, v254, v130
    v_mul_f32 v255, v255, v131
    v_exp_f32 v252, v252
    v_mfma_f32_32x32x16_bf16 v[160:175], v[8:11], a[208:211], v[160:175]
    ds_read_b128 a[240:243], v202 offset:8192
    v_exp_f32 v253, v253
    v_exp_f32 v254, v254
    v_exp_f32 v255, v255
    v_mfma_f32_32x32x16_bf16 v[176:191], v[8:11], a[212:215], v[176:191]
    ds_read_b128 a[244:247], v202 offset:12288
    v_fma_f32 v252, v252, v209, v209
    v_fma_f32 v253, v253, v209, v209
    v_fma_f32 v254, v254, v209, v209
    v_fma_f32 v255, v255, v209, v209
    v_rcp_f32 v252, v252
    v_mfma_f32_32x32x16_bf16 v[160:175], v[12:15], a[216:219], v[160:175]
    ds_read_b128 a[248:251], v203 offset:8192
    v_rcp_f32 v253, v253
    v_rcp_f32 v254, v254
    v_rcp_f32 v255, v255
    v_mfma_f32_32x32x16_bf16 v[176:191], v[12:15], a[220:223], v[176:191]
    s_waitcnt lgkmcnt(3)
    ds_read_b128 a[252:255], v203 offset:12288
    v_mul_f32 v128, v128, v252
    v_mul_f32 v129, v129, v253
    v_mul_f32 v130, v130, v254
    v_mul_f32 v131, v131, v255
    v_mul_f32 v252, v132, v132
    v_mul_f32 v253, v133, v133
    v_mfma_f32_32x32x16_bf16 v[160:175], v[16:19], a[224:227], v[160:175]
    ds_read_b128 a[192:195], v200 offset:16384
    buffer_store_dwordx4 a[188:191], v206, s[60:63], s13 offen offset:0 sc1
    v_mfma_f32_32x32x16_bf16 v[176:191], v[16:19], a[228:231], v[176:191]
    ds_read_b128 a[196:199], v200 offset:20480
    v_mul_f32 v254, v134, v134
    v_mul_f32 v255, v135, v135
    v_fma_f32 v252, v252, v211, v210
    v_fma_f32 v253, v253, v211, v210
    v_fma_f32 v254, v254, v211, v210
    v_mfma_f32_32x32x16_bf16 v[160:175], v[20:23], a[232:235], v[160:175]
    ds_read_b128 a[200:203], v201 offset:16384
    buffer_store_dwordx4 a[188:191], v206, s[60:63], s13 offen offset:1024 sc1
    v_mfma_f32_32x32x16_bf16 v[176:191], v[20:23], a[236:239], v[176:191]
    s_waitcnt lgkmcnt(3)
    ds_read_b128 a[204:207], v201 offset:20480
    v_fma_f32 v255, v255, v211, v210
    v_mul_f32 v252, v252, v132
    v_mul_f32 v253, v253, v133
    v_mul_f32 v254, v254, v134
    v_mfma_f32_32x32x16_bf16 v[160:175], v[24:27], a[240:243], v[160:175]
    ds_read_b128 a[208:211], v202 offset:16384
    s_add_u32 m0, s3, 0
    s_add_u32 s94, s28, 128
    buffer_load_dwordx4 v196, s[68:71], s94 offen offset:0 lds
    v_mul_f32 v255, v255, v135
    v_mfma_f32_32x32x16_bf16 v[176:191], v[24:27], a[244:247], v[176:191]
    ds_read_b128 a[212:215], v202 offset:20480
    buffer_load_dwordx4 v197, s[68:71], s94 offen offset:1024 lds
    v_exp_f32 v252, v252
    v_exp_f32 v253, v253
    v_mfma_f32_32x32x16_bf16 v[160:175], v[28:31], a[248:251], v[160:175]
    ds_read_b128 a[216:219], v203 offset:16384
    v_exp_f32 v254, v254
    v_exp_f32 v255, v255
    v_fma_f32 v252, v252, v209, v209
    v_fma_f32 v253, v253, v209, v209
    v_mfma_f32_32x32x16_bf16 v[176:191], v[28:31], a[252:255], v[176:191]
    s_waitcnt lgkmcnt(3)
    ds_read_b128 a[220:223], v203 offset:20480
    buffer_load_dwordx4 v198, s[68:71], s94 offen offset:2048 lds
    v_fma_f32 v254, v254, v209, v209
    v_fma_f32 v255, v255, v209, v209
    v_mfma_f32_32x32x16_bf16 v[160:175], v[32:35], a[192:195], v[160:175]
    ds_read_b128 a[224:227], v200 offset:24576
    v_rcp_f32 v252, v252
    v_rcp_f32 v253, v253
    v_rcp_f32 v254, v254
    v_mfma_f32_32x32x16_bf16 v[176:191], v[32:35], a[196:199], v[176:191]
    ds_read_b128 a[228:231], v200 offset:28672
    buffer_load_dwordx4 v199, s[68:71], s94 offen offset:3072 lds
    v_rcp_f32 v255, v255
    v_mul_f32 v132, v132, v252
    v_mul_f32 v133, v133, v253
    v_mfma_f32_32x32x16_bf16 v[160:175], v[36:39], a[200:203], v[160:175]
    ds_read_b128 a[232:235], v201 offset:24576
    v_mul_f32 v134, v134, v254
    v_mul_f32 v135, v135, v255
    v_cvt_pk_bf16_f32 v128, v128, v129
    v_cvt_pk_bf16_f32 v129, v130, v131
    v_cvt_pk_bf16_f32 v130, v132, v133
    v_cvt_pk_bf16_f32 v131, v134, v135
    v_mfma_f32_32x32x16_bf16 v[176:191], v[36:39], a[204:207], v[176:191]
    s_waitcnt lgkmcnt(3)
    ds_read_b128 a[236:239], v201 offset:28672
    s_add_u32 m0, s3, 4096
    s_add_u32 s94, s28, 114816
    buffer_load_dwordx4 v196, s[68:71], s94 offen offset:0 lds
    v_mfma_f32_32x32x16_bf16 v[160:175], v[40:43], a[208:211], v[160:175]
    ds_read_b128 a[240:243], v202 offset:24576
    buffer_store_dwordx4 v[128:131], v206, s[60:63], s99 offen offset:0 sc1
    v_mfma_f32_32x32x16_bf16 v[176:191], v[40:43], a[212:215], v[176:191]
    ds_read_b128 a[244:247], v202 offset:28672
    buffer_load_dwordx4 v197, s[68:71], s94 offen offset:1024 lds
    v_mul_f32 v252, v136, v136
    v_mul_f32 v253, v137, v137
    v_mul_f32 v254, v138, v138
    v_mfma_f32_32x32x16_bf16 v[160:175], v[44:47], a[216:219], v[160:175]
    ds_read_b128 a[248:251], v203 offset:24576
    v_mul_f32 v255, v139, v139
    v_fma_f32 v252, v252, v211, v210
    v_fma_f32 v253, v253, v211, v210
    v_fma_f32 v254, v254, v211, v210
    v_fma_f32 v255, v255, v211, v210
    v_mul_f32 v252, v252, v136
    v_mfma_f32_32x32x16_bf16 v[176:191], v[44:47], a[220:223], v[176:191]
    s_waitcnt lgkmcnt(3)
    ds_read_b128 a[252:255], v203 offset:28672
    buffer_load_dwordx4 v198, s[68:71], s94 offen offset:2048 lds
    s_load_dwordx16 s[44:59], s[4:5], 0 glc
    v_mul_f32 v253, v253, v137
    s_barrier
    v_mfma_f32_32x32x16_bf16 v[160:175], v[48:51], a[224:227], v[160:175]
    ds_read_b128 a[192:195], v200 offset:32768
    v_mul_f32 v254, v254, v138
    v_mul_f32 v255, v255, v139
    v_exp_f32 v252, v252
    v_mfma_f32_32x32x16_bf16 v[176:191], v[48:51], a[228:231], v[176:191]
    ds_read_b128 a[196:199], v200 offset:36864
    buffer_load_dwordx4 v199, s[68:71], s94 offen offset:3072 lds
    v_exp_f32 v253, v253
    v_exp_f32 v254, v254
    v_mfma_f32_32x32x16_bf16 v[160:175], v[52:55], a[232:235], v[160:175]
    ds_read_b128 a[200:203], v201 offset:32768
    v_accvgpr_read_b32 v195, a184
    v_accvgpr_read_b32 v194, a185
    v_exp_f32 v255, v255
    v_fma_f32 v252, v252, v209, v209
    v_fma_f32 v253, v253, v209, v209
    v_mfma_f32_32x32x16_bf16 v[176:191], v[52:55], a[236:239], v[176:191]
    s_waitcnt lgkmcnt(3)
    ds_read_b128 a[204:207], v201 offset:36864
    v_accvgpr_read_b32 v193, a183
    v_fma_f32 v254, v254, v209, v209
    v_fma_f32 v255, v255, v209, v209
    v_rcp_f32 v252, v252
    v_mfma_f32_32x32x16_bf16 v[160:175], v[56:59], a[240:243], v[160:175]
    ds_read_b128 a[208:211], v202 offset:32768
    v_mov_b32 v250, 0
    v_mov_b32 v251, 0
    v_rcp_f32 v253, v253
    v_rcp_f32 v254, v254
    v_mfma_f32_32x32x16_bf16 v[176:191], v[56:59], a[244:247], v[176:191]
    ds_read_b128 a[212:215], v202 offset:36864
    v_rcp_f32 v255, v255
    v_mul_f32 v136, v136, v252
    v_mul_f32 v137, v137, v253
    v_mul_f32 v138, v138, v254
    v_mul_f32 v139, v139, v255
    v_mfma_f32_32x32x16_bf16 v[160:175], v[60:63], a[248:251], v[160:175]
    ds_read_b128 a[216:219], v203 offset:32768
    ds_write_b32 v195, v208
    v_mul_f32 v252, v140, v140
    v_mul_f32 v253, v141, v141
    v_mul_f32 v254, v142, v142
    v_mfma_f32_32x32x16_bf16 v[176:191], v[60:63], a[252:255], v[176:191]
    s_waitcnt lgkmcnt(4)
    ds_read_b128 a[220:223], v203 offset:36864
    v_mul_f32 v255, v143, v143
    v_fma_f32 v252, v252, v211, v210
    v_fma_f32 v253, v253, v211, v210
    v_fma_f32 v254, v254, v211, v210
    v_fma_f32 v255, v255, v211, v210
    v_mfma_f32_32x32x16_bf16 v[160:175], v[64:67], a[192:195], v[160:175]
    ds_read_b128 a[224:227], v200 offset:40960
    s_waitcnt vmcnt(9)
    buffer_store_dword v240, v241, s[60:63], s7 offen sc1
    v_mul_f32 v252, v252, v140
    v_mul_f32 v253, v253, v141
    v_mfma_f32_32x32x16_bf16 v[176:191], v[64:67], a[196:199], v[176:191]
    ds_read_b128 a[228:231], v200 offset:45056
    v_mul_f32 v254, v254, v142
    v_mul_f32 v255, v255, v143
    v_exp_f32 v252, v252
    v_exp_f32 v253, v253
    v_mfma_f32_32x32x16_bf16 v[160:175], v[68:71], a[200:203], v[160:175]
    ds_read_b128 a[232:235], v201 offset:40960
    ds_write_b32 v195, v207 offset:512
    v_exp_f32 v254, v254
    v_mfma_f32_32x32x16_bf16 v[176:191], v[68:71], a[204:207], v[176:191]
    s_waitcnt lgkmcnt(4)
    ds_read_b128 a[236:239], v201 offset:45056
    v_exp_f32 v255, v255
    v_fma_f32 v252, v252, v209, v209
    v_fma_f32 v253, v253, v209, v209
    v_fma_f32 v254, v254, v209, v209
    v_fma_f32 v255, v255, v209, v209
    v_mfma_f32_32x32x16_bf16 v[160:175], v[72:75], a[208:211], v[160:175]
    ds_read_b128 a[240:243], v202 offset:40960
    v_rcp_f32 v252, v252
    v_rcp_f32 v253, v253
    v_rcp_f32 v254, v254
    v_mfma_f32_32x32x16_bf16 v[176:191], v[72:75], a[212:215], v[176:191]
    ds_read_b128 a[244:247], v202 offset:45056
    ds_write_b64 v194, v[250:251]
    v_rcp_f32 v255, v255
    v_mfma_f32_32x32x16_bf16 v[160:175], v[76:79], a[216:219], v[160:175]
    ds_read_b128 a[248:251], v203 offset:40960
    v_mul_f32 v140, v140, v252
    v_mul_f32 v141, v141, v253
    v_mul_f32 v142, v142, v254
    v_mul_f32 v143, v143, v255
    v_cvt_pk_bf16_f32 v136, v136, v137
    v_cvt_pk_bf16_f32 v137, v138, v139
    v_mfma_f32_32x32x16_bf16 v[176:191], v[76:79], a[220:223], v[176:191]
    s_waitcnt lgkmcnt(4)
    ds_read_b128 a[252:255], v203 offset:45056
    v_cvt_pk_bf16_f32 v138, v140, v141
    v_cvt_pk_bf16_f32 v139, v142, v143
    buffer_store_dwordx4 v[136:139], v206, s[60:63], s99 offen offset:1024 sc1
    v_mfma_f32_32x32x16_bf16 v[160:175], v[80:83], a[224:227], v[160:175]
    ds_read_b128 a[192:195], v200 offset:49152
    s_mov_b32 s96, 0
L_bf:
    s_waitcnt lgkmcnt(0)
    s_and_b64 s[44:45], s[44:45], s[46:47]
    s_and_b64 s[44:45], s[44:45], s[48:49]
    s_and_b64 s[44:45], s[44:45], s[50:51]
    s_and_b64 s[44:45], s[44:45], s[52:53]
    s_and_b32 s44, s44, s54
    s_and_b32 s44, s44, s45
    s_cbranch_scc1 L_bf_done
    s_add_u32 s96, s96, 1
    s_cmp_ge_u32 s96, 100000
    s_cbranch_scc1 L_bf_done
    s_load_dwordx16 s[44:59], s[4:5], 0 glc
    s_branch L_bf
L_bf_done:
    v_mul_f32 v252, v144, v144
    v_mfma_f32_32x32x16_bf16 v[176:191], v[80:83], a[228:231], v[176:191]
    ds_read_b128 a[196:199], v200 offset:53248
    s_add_u32 s24, s17, 0
    buffer_load_dwordx4 a[0:3], v206, s[60:63], s24 offen offset:0 sc1
    v_mul_f32 v253, v145, v145
    v_mul_f32 v254, v146, v146
    v_mfma_f32_32x32x16_bf16 v[160:175], v[84:87], a[232:235], v[160:175]
    ds_read_b128 a[200:203], v201 offset:49152
    s_add_u32 s25, s17, 180224
    buffer_load_dwordx4 a[4:7], v206, s[60:63], s25 offen offset:0 sc1
    v_mul_f32 v255, v147, v147
    v_fma_f32 v252, v252, v211, v210
    v_mfma_f32_32x32x16_bf16 v[176:191], v[84:87], a[236:239], v[176:191]
    ds_read_b128 a[204:207], v201 offset:53248
    v_fma_f32 v253, v253, v211, v210
    v_fma_f32 v254, v254, v211, v210
    v_fma_f32 v255, v255, v211, v210
    v_mul_f32 v252, v252, v144
    v_mul_f32 v253, v253, v145
    v_mul_f32 v254, v254, v146
    v_mfma_f32_32x32x16_bf16 v[160:175], v[88:91], a[240:243], v[160:175]
    ds_read_b128 a[208:211], v202 offset:49152
    buffer_load_dwordx4 a[8:11], v206, s[60:63], s24 offen offset:1024 sc1
    v_mul_f32 v255, v255, v147
    v_exp_f32 v252, v252
    v_mfma_f32_32x32x16_bf16 v[176:191], v[88:91], a[244:247], v[176:191]
    ds_read_b128 a[212:215], v202 offset:53248
    v_exp_f32 v253, v253
    v_exp_f32 v254, v254
    v_exp_f32 v255, v255
    v_mfma_f32_32x32x16_bf16 v[160:175], v[92:95], a[248:251], v[160:175]
    ds_read_b128 a[216:219], v203 offset:49152
    buffer_load_dwordx4 a[12:15], v206, s[60:63], s25 offen offset:1024 sc1
    v_fma_f32 v252, v252, v209, v209
    v_fma_f32 v253, v253, v209, v209
    v_fma_f32 v254, v254, v209, v209
    v_mfma_f32_32x32x16_bf16 v[176:191], v[92:95], a[252:255], v[176:191]
    s_waitcnt lgkmcnt(3)
    ds_read_b128 a[220:223], v203 offset:53248
    v_fma_f32 v255, v255, v209, v209
    v_rcp_f32 v252, v252
    v_rcp_f32 v253, v253
    v_mfma_f32_32x32x16_bf16 v[160:175], v[96:99], a[192:195], v[160:175]
    ds_read_b128 a[224:227], v200 offset:57344
    s_add_u32 s24, s17, 4096
    buffer_load_dwordx4 a[16:19], v206, s[60:63], s24 offen offset:0 sc1
    v_rcp_f32 v254, v254
    v_mfma_f32_32x32x16_bf16 v[176:191], v[96:99], a[196:199], v[176:191]
    ds_read_b128 a[228:231], v200 offset:61440
    v_rcp_f32 v255, v255
    v_mul_f32 v144, v144, v252
    v_mul_f32 v145, v145, v253
    v_mul_f32 v146, v146, v254
    v_mul_f32 v147, v147, v255
    v_mul_f32 v252, v148, v148
    v_mfma_f32_32x32x16_bf16 v[160:175], v[100:103], a[200:203], v[160:175]
    ds_read_b128 a[232:235], v201 offset:57344
    s_add_u32 s25, s17, 184320
    buffer_load_dwordx4 a[20:23], v206, s[60:63], s25 offen offset:0 sc1
    v_mul_f32 v253, v149, v149
    v_mul_f32 v254, v150, v150
    v_mfma_f32_32x32x16_bf16 v[176:191], v[100:103], a[204:207], v[176:191]
    s_waitcnt lgkmcnt(3)
    ds_read_b128 a[236:239], v201 offset:61440
    v_mul_f32 v255, v151, v151
    v_fma_f32 v252, v252, v211, v210
    v_fma_f32 v253, v253, v211, v210
    v_fma_f32 v254, v254, v211, v210
    v_fma_f32 v255, v255, v211, v210
    v_mfma_f32_32x32x16_bf16 v[160:175], v[104:107], a[208:211], v[160:175]
    ds_read_b128 a[240:243], v202 offset:57344
    buffer_load_dwordx4 a[24:27], v206, s[60:63], s24 offen offset:1024 sc1
    v_mul_f32 v252, v252, v148
    v_mul_f32 v253, v253, v149
    v_mul_f32 v254, v254, v150
    v_mul_f32 v255, v255, v151
    v_mfma_f32_32x32x16_bf16 v[176:191], v[104:107], a[212:215], v[176:191]
    ds_read_b128 a[244:247], v202 offset:61440
    v_exp_f32 v252, v252
    v_exp_f32 v253, v253
    v_exp_f32 v254, v254
    v_mfma_f32_32x32x16_bf16 v[160:175], v[108:111], a[216:219], v[160:175]
    ds_read_b128 a[248:251], v203 offset:57344
    buffer_load_dwordx4 a[28:31], v206, s[60:63], s25 offen offset:1024 sc1
    v_exp_f32 v255, v255
    v_fma_f32 v252, v252, v209, v209
    v_mfma_f32_32x32x16_bf16 v[176:191], v[108:111], a[220:223], v[176:191]
    s_waitcnt lgkmcnt(3)
    ds_read_b128 a[252:255], v203 offset:61440
    v_fma_f32 v253, v253, v209, v209
    v_fma_f32 v254, v254, v209, v209
    v_fma_f32 v255, v255, v209, v209
    v_rcp_f32 v252, v252
    s_barrier
    v_add_u32 v204, 131072, v204
    v_add_u32 v205, 131072, v205
    v_mfma_f32_32x32x16_bf16 v[160:175], v[112:115], a[224:227], v[160:175]
    ds_read_b64_tr_b16 a[192:193], v204 offset:0
    ds_read_b64_tr_b16 a[194:195], v204 offset:512
    s_add_u32 s24, s17, 8192
    buffer_load_dwordx4 a[32:35], v206, s[60:63], s24 offen offset:0 sc1
    v_mfma_f32_32x32x16_bf16 v[176:191], v[112:115], a[228:231], v[176:191]
    ds_read_b64_tr_b16 a[196:197], v205 offset:0
    ds_read_b64_tr_b16 a[198:199], v205 offset:512
    v_rcp_f32 v253, v253
    v_mfma_f32_32x32x16_bf16 v[160:175], v[116:119], a[232:235], v[160:175]
    ds_read_b64_tr_b16 a[200:201], v204 offset:2048
    ds_read_b64_tr_b16 a[202:203], v204 offset:2560
    s_add_u32 s25, s17, 188416
    buffer_load_dwordx4 a[36:39], v206, s[60:63], s25 offen offset:0 sc1
    v_rcp_f32 v254, v254
    v_mfma_f32_32x32x16_bf16 v[176:191], v[116:119], a[236:239], v[176:191]
    s_waitcnt lgkmcnt(6)
    ds_read_b64_tr_b16 a[204:205], v205 offset:2048
    ds_read_b64_tr_b16 a[206:207], v205 offset:2560
    v_rcp_f32 v255, v255
    v_mul_f32 v148, v148, v252
    v_mul_f32 v149, v149, v253
    v_mfma_f32_32x32x16_bf16 v[160:175], v[120:123], a[240:243], v[160:175]
    ds_read_b64_tr_b16 a[208:209], v204 offset:4096
    ds_read_b64_tr_b16 a[210:211], v204 offset:4608
    buffer_load_dwordx4 a[40:43], v206, s[60:63], s24 offen offset:1024 sc1
    ds_read_b128 v[200:203], v193
    v_mul_f32 v150, v150, v254
    v_mfma_f32_32x32x16_bf16 v[176:191], v[120:123], a[244:247], v[176:191]
    ds_read_b64_tr_b16 a[212:213], v205 offset:4096
    ds_read_b64_tr_b16 a[214:215], v205 offset:4608
    v_mul_f32 v151, v151, v255
    v_cvt_pk_bf16_f32 v144, v144, v145
    v_cvt_pk_bf16_f32 v145, v146, v147
    v_cvt_pk_bf16_f32 v146, v148, v149
    v_cvt_pk_bf16_f32 v147, v150, v151
    v_mfma_f32_32x32x16_bf16 v[160:175], v[124:127], a[248:251], v[160:175]
    ds_read_b64_tr_b16 a[216:217], v204 offset:6144
    ds_read_b64_tr_b16 a[218:219], v204 offset:6656
    buffer_load_dwordx4 a[44:47], v206, s[60:63], s25 offen offset:1024 sc1
    v_mfma_f32_32x32x16_bf16 v[176:191], v[124:127], a[252:255], v[176:191]
    s_waitcnt lgkmcnt(7)
    ds_read_b64_tr_b16 a[220:221], v205 offset:6144
    ds_read_b64_tr_b16 a[222:223], v205 offset:6656
    buffer_store_dwordx4 v[144:147], v206, s[60:63], s99 offen offset:2048 sc1
    v_pk_mul_f32 v[252:253], v[152:153], v[152:153]
    v_pk_mul_f32 v[254:255], v[154:155], v[154:155]
    v_pk_fma_f32 v[252:253], v[252:253], v[210:211], v[210:211] op_sel:[0,1,0] op_sel_hi:[1,1,0]
    v_pk_fma_f32 v[254:255], v[254:255], v[210:211], v[210:211] op_sel:[0,1,0] op_sel_hi:[1,1,0]
    v_pk_mul_f32 v[252:253], v[252:253], v[152:153]
    v_pk_mul_f32 v[254:255], v[254:255], v[154:155]
    v_exp_f32 v252, v252
    v_exp_f32 v253, v253
    v_exp_f32 v254, v254
    v_exp_f32 v255, v255
    v_pk_fma_f32 v[252:253], v[252:253], v[208:209], v[208:209] op_sel:[0,1,1] op_sel_hi:[1,1,1]
    v_pk_fma_f32 v[254:255], v[254:255], v[208:209], v[208:209] op_sel:[0,1,1] op_sel_hi:[1,1,1]
    v_rcp_f32 v252, v252
    v_rcp_f32 v253, v253
    v_rcp_f32 v254, v254
    v_rcp_f32 v255, v255
    v_pk_mul_f32 v[152:153], v[152:153], v[252:253]
    v_pk_mul_f32 v[154:155], v[154:155], v[254:255]
    v_pk_mul_f32 v[252:253], v[156:157], v[156:157]
    v_pk_mul_f32 v[254:255], v[158:159], v[158:159]
    v_pk_fma_f32 v[252:253], v[252:253], v[210:211], v[210:211] op_sel:[0,1,0] op_sel_hi:[1,1,0]
    v_pk_fma_f32 v[254:255], v[254:255], v[210:211], v[210:211] op_sel:[0,1,0] op_sel_hi:[1,1,0]
    v_pk_mul_f32 v[252:253], v[252:253], v[156:157]
    v_pk_mul_f32 v[254:255], v[254:255], v[158:159]
    v_exp_f32 v252, v252
    v_exp_f32 v253, v253
    v_exp_f32 v254, v254
    v_exp_f32 v255, v255
    v_pk_fma_f32 v[252:253], v[252:253], v[208:209], v[208:209] op_sel:[0,1,1] op_sel_hi:[1,1,1]
    v_pk_fma_f32 v[254:255], v[254:255], v[208:209], v[208:209] op_sel:[0,1,1] op_sel_hi:[1,1,1]
    v_rcp_f32 v252, v252
    v_rcp_f32 v253, v253
    v_rcp_f32 v254, v254
    v_rcp_f32 v255, v255
    v_pk_mul_f32 v[156:157], v[156:157], v[252:253]
    v_pk_mul_f32 v[158:159], v[158:159], v[254:255]
    v_cvt_pk_bf16_f32 v152, v152, v153
    v_cvt_pk_bf16_f32 v153, v154, v155
    v_cvt_pk_bf16_f32 v154, v156, v157
    v_cvt_pk_bf16_f32 v155, v158, v159
    buffer_store_dwordx4 v[152:155], v206, s[60:63], s99 offen offset:3072 sc1
    v_mfma_f32_32x32x16_bf16 v[128:143], v[228:231], v[230:233], 0
    v_mfma_f32_32x32x16_bf16 v[128:143], a[192:195], v[0:3], v[128:143]
    ds_read_b64_tr_b16 a[224:225], v204 offset:8192
    ds_read_b64_tr_b16 a[226:227], v204 offset:8704
    s_add_u32 s24, s17, 12288
    buffer_load_dwordx4 a[48:51], v206, s[60:63], s24 offen offset:0 sc1
    v_mfma_f32_32x32x16_bf16 v[144:159], v[228:231], v[234:237], 0
    v_mfma_f32_32x32x16_bf16 v[144:159], a[196:199], v[0:3], v[144:159]
    ds_read_b64_tr_b16 a[228:229], v205 offset:8192
    ds_read_b64_tr_b16 a[230:231], v205 offset:8704
    s_waitcnt lgkmcnt(10)
    v_mul_f32 v160, v160, v200
    v_mul_f32 v176, v176, v200
    v_mul_f32 v161, v161, v201
    v_mul_f32 v177, v177, v201
    v_mul_f32 v162, v162, v202
    v_mfma_f32_32x32x16_bf16 v[128:143], a[200:203], v[4:7], v[128:143]
    ds_read_b64_tr_b16 a[232:233], v204 offset:10240
    ds_read_b64_tr_b16 a[234:235], v204 offset:10752
    s_add_u32 s25, s17, 192512
    buffer_load_dwordx4 a[52:55], v206, s[60:63], s25 offen offset:0 sc1
    v_mul_f32 v178, v178, v202
    v_mul_f32 v163, v163, v203
    v_mfma_f32_32x32x16_bf16 v[144:159], a[204:207], v[4:7], v[144:159]
    s_waitcnt lgkmcnt(6)
    ds_read_b64_tr_b16 a[236:237], v205 offset:10240
    ds_read_b64_tr_b16 a[238:239], v205 offset:10752
    v_mul_f32 v179, v179, v203
    ds_read_b128 v[200:203], v193 offset:16
    v_fma_f32 v246, v212, v160, v161
    v_fma_f32 v247, v212, v176, v177
    v_fma_f32 v246, -v213, v176, v246
    v_fmac_f32 v247, v213, v160
    v_mfma_f32_32x32x16_bf16 v[128:143], a[208:211], v[8:11], v[128:143]
    ds_read_b64_tr_b16 a[240:241], v204 offset:12288
    ds_read_b64_tr_b16 a[242:243], v204 offset:12800
    buffer_load_dwordx4 a[56:59], v206, s[60:63], s24 offen offset:1024 sc1
    v_fma_f32 v224, v212, v246, v162
    v_fma_f32 v225, v212, v247, v178
    v_fma_f32 v224, -v213, v247, v224
    v_fmac_f32 v225, v213, v246
    v_mfma_f32_32x32x16_bf16 v[144:159], a[212:215], v[8:11], v[144:159]
    ds_read_b64_tr_b16 a[244:245], v205 offset:12288
    ds_read_b64_tr_b16 a[246:247], v205 offset:12800
    v_fma_f32 v246, v212, v224, v163
    v_fma_f32 v247, v212, v225, v179
    v_fma_f32 v246, -v213, v225, v246
    v_fmac_f32 v247, v213, v224
    s_waitcnt lgkmcnt(4)
    v_mul_f32 v164, v164, v200
    v_mul_f32 v180, v180, v200
    v_mfma_f32_32x32x16_bf16 v[128:143], a[216:219], v[12:15], v[128:143]
    ds_read_b64_tr_b16 a[248:249], v204 offset:14336
    ds_read_b64_tr_b16 a[250:251], v204 offset:14848
    buffer_load_dwordx4 a[60:63], v206, s[60:63], s25 offen offset:1024 sc1
    v_mul_f32 v165, v165, v201
    v_mul_f32 v181, v181, v201
    v_mul_f32 v166, v166, v202
    v_mul_f32 v182, v182, v202
    v_mfma_f32_32x32x16_bf16 v[144:159], a[220:223], v[12:15], v[144:159]
    ds_read_b64_tr_b16 a[252:253], v205 offset:14336
    ds_read_b64_tr_b16 a[254:255], v205 offset:14848
    v_mul_f32 v167, v167, v203
    v_mul_f32 v183, v183, v203
    ds_read_b128 v[200:203], v193 offset:32
    v_fma_f32 v224, v212, v246, v164
    v_fma_f32 v225, v212, v247, v180
    v_fma_f32 v224, -v213, v247, v224
    v_mfma_f32_32x32x16_bf16 v[128:143], a[224:227], v[16:19], v[128:143]
    ds_read_b64_tr_b16 a[192:193], v204 offset:16384
    ds_read_b64_tr_b16 a[194:195], v204 offset:16896
    s_add_u32 s24, s17, 16384
    buffer_load_dwordx4 a[64:67], v206, s[60:63], s24 offen offset:0 sc1
    v_fmac_f32 v225, v213, v246
    v_fma_f32 v246, v212, v224, v165
    v_mfma_f32_32x32x16_bf16 v[144:159], a[228:231], v[16:19], v[144:159]
    ds_read_b64_tr_b16 a[196:197], v205 offset:16384
    ds_read_b64_tr_b16 a[198:199], v205 offset:16896
    v_fma_f32 v247, v212, v225, v181
    v_fma_f32 v246, -v213, v225, v246
    v_fmac_f32 v247, v213, v224
    v_fma_f32 v224, v212, v246, v166
    v_fma_f32 v225, v212, v247, v182
    v_fma_f32 v224, -v213, v247, v224
    v_fmac_f32 v225, v213, v246
    v_mfma_f32_32x32x16_bf16 v[128:143], a[232:235], v[20:23], v[128:143]
    ds_read_b64_tr_b16 a[200:201], v204 offset:18432
    ds_read_b64_tr_b16 a[202:203], v204 offset:18944
    s_add_u32 s25, s17, 196608
    buffer_load_dwordx4 a[68:71], v206, s[60:63], s25 offen offset:0 sc1
    v_fma_f32 v246, v212, v224, v167
    v_fma_f32 v247, v212, v225, v183
    v_fma_f32 v246, -v213, v225, v246
    v_mfma_f32_32x32x16_bf16 v[144:159], a[236:239], v[20:23], v[144:159]
    s_waitcnt lgkmcnt(7)
    ds_read_b64_tr_b16 a[204:205], v205 offset:18432
    ds_read_b64_tr_b16 a[206:207], v205 offset:18944
    v_fmac_f32 v247, v213, v224
    s_waitcnt lgkmcnt(8)
    v_mul_f32 v168, v168, v200
    v_mul_f32 v184, v184, v200
    v_mul_f32 v169, v169, v201
    v_mul_f32 v185, v185, v201
    v_mfma_f32_32x32x16_bf16 v[128:143], a[240:243], v[24:27], v[128:143]
    ds_read_b64_tr_b16 a[208:209], v204 offset:20480
    ds_read_b64_tr_b16 a[210:211], v204 offset:20992
    buffer_load_dwordx4 a[72:75], v206, s[60:63], s24 offen offset:1024 sc1
    v_mul_f32 v170, v170, v202
    v_mul_f32 v186, v186, v202
    v_mul_f32 v171, v171, v203
    v_mul_f32 v187, v187, v203
    v_mfma_f32_32x32x16_bf16 v[144:159], a[244:247], v[24:27], v[144:159]
    ds_read_b64_tr_b16 a[212:213], v205 offset:20480
    ds_read_b64_tr_b16 a[214:215], v205 offset:20992
    ds_read_b128 v[200:203], v193 offset:48
    v_fma_f32 v224, v212, v246, v168
    v_fma_f32 v225, v212, v247, v184
    v_fma_f32 v224, -v213, v247, v224
    v_fmac_f32 v225, v213, v246
    v_fma_f32 v246, v212, v224, v169
    v_mfma_f32_32x32x16_bf16 v[128:143], a[248:251], v[28:31], v[128:143]
    ds_read_b64_tr_b16 a[216:217], v204 offset:22528
    ds_read_b64_tr_b16 a[218:219], v204 offset:23040
    buffer_load_dwordx4 a[76:79], v206, s[60:63], s25 offen offset:1024 sc1
    v_fma_f32 v247, v212, v225, v185
    v_fma_f32 v246, -v213, v225, v246
    v_fmac_f32 v247, v213, v224
    v_fma_f32 v224, v212, v246, v170
    v_mfma_f32_32x32x16_bf16 v[144:159], a[252:255], v[28:31], v[144:159]
    s_waitcnt lgkmcnt(7)
    ds_read_b64_tr_b16 a[220:221], v205 offset:22528
    ds_read_b64_tr_b16 a[222:223], v205 offset:23040
    v_fma_f32 v225, v212, v247, v186
    v_fma_f32 v224, -v213, v247, v224
    v_fmac_f32 v225, v213, v246
    v_fma_f32 v246, v212, v224, v171
    v_fma_f32 v247, v212, v225, v187
    v_fma_f32 v246, -v213, v225, v246
    v_mfma_f32_32x32x16_bf16 v[128:143], a[192:195], v[32:35], v[128:143]
    ds_read_b64_tr_b16 a[224:225], v204 offset:24576
    ds_read_b64_tr_b16 a[226:227], v204 offset:25088
    s_add_u32 s24, s17, 20480
    buffer_load_dwordx4 a[80:83], v206, s[60:63], s24 offen offset:0 sc1
    v_fmac_f32 v247, v213, v224
    s_waitcnt lgkmcnt(6)
    v_mul_f32 v172, v172, v200
    v_mfma_f32_32x32x16_bf16 v[144:159], a[196:199], v[32:35], v[144:159]
    ds_read_b64_tr_b16 a[228:229], v205 offset:24576
    ds_read_b64_tr_b16 a[230:231], v205 offset:25088
    v_mul_f32 v188, v188, v200
    v_mul_f32 v173, v173, v201
    v_mul_f32 v189, v189, v201
    v_mul_f32 v174, v174, v202
    v_mul_f32 v190, v190, v202
    v_mul_f32 v175, v175, v203
    v_mul_f32 v191, v191, v203
    v_mfma_f32_32x32x16_bf16 v[128:143], a[200:203], v[36:39], v[128:143]
    ds_read_b64_tr_b16 a[232:233], v204 offset:26624
    ds_read_b64_tr_b16 a[234:235], v204 offset:27136
    s_add_u32 s25, s17, 200704
    buffer_load_dwordx4 a[84:87], v206, s[60:63], s25 offen offset:0 sc1
    s_waitcnt vmcnt(10)
    buffer_store_dword v240, v239, s[60:63], s29 offen offset:0 sc1
    v_mfma_f32_32x32x16_bf16 v[144:159], a[204:207], v[36:39], v[144:159]
    s_waitcnt lgkmcnt(6)
    ds_read_b64_tr_b16 a[236:237], v205 offset:26624
    ds_read_b64_tr_b16 a[238:239], v205 offset:27136
    v_fma_f32 v224, v212, v246, v172
    v_fma_f32 v225, v212, v247, v188
    v_fma_f32 v224, -v213, v247, v224
    v_fmac_f32 v225, v213, v246
    v_mfma_f32_32x32x16_bf16 v[128:143], a[208:211], v[40:43], v[128:143]
    ds_read_b64_tr_b16 a[240:241], v204 offset:28672
    ds_read_b64_tr_b16 a[242:243], v204 offset:29184
    buffer_load_dwordx4 a[88:91], v206, s[60:63], s24 offen offset:1024 sc1
    v_fma_f32 v246, v212, v224, v173
    v_fma_f32 v247, v212, v225, v189
    v_fma_f32 v246, -v213, v225, v246
    v_fmac_f32 v247, v213, v224
    v_mfma_f32_32x32x16_bf16 v[144:159], a[212:215], v[40:43], v[144:159]
    ds_read_b64_tr_b16 a[244:245], v205 offset:28672
    ds_read_b64_tr_b16 a[246:247], v205 offset:29184
    buffer_load_dwordx4 a[92:95], v206, s[60:63], s25 offen offset:1024 sc1
    v_fma_f32 v224, v212, v246, v174
    v_fma_f32 v225, v212, v247, v190
    v_fma_f32 v224, -v213, v247, v224
    v_fmac_f32 v225, v213, v246
    v_mfma_f32_32x32x16_bf16 v[128:143], a[216:219], v[44:47], v[128:143]
    ds_read_b64_tr_b16 a[248:249], v204 offset:30720
    ds_read_b64_tr_b16 a[250:251], v204 offset:31232
    v_fma_f32 v246, v212, v224, v175
    v_fma_f32 v247, v212, v225, v191
    v_fma_f32 v246, -v213, v225, v246
    v_fmac_f32 v247, v213, v224
    ds_write_b64 v194, v[246:247] offset:2048
    v_mfma_f32_32x32x16_bf16 v[144:159], a[220:223], v[44:47], v[144:159]
    s_waitcnt lgkmcnt(7)
    ds_read_b64_tr_b16 a[252:253], v205 offset:30720
    ds_read_b64_tr_b16 a[254:255], v205 offset:31232
    s_add_u32 s24, s17, 24576
    buffer_load_dwordx4 a[96:99], v206, s[60:63], s24 offen offset:0 sc1
    s_waitcnt lgkmcnt(2)
    s_barrier
    v_subrev_u32 v204, 131072, v204
    v_subrev_u32 v205, 131072, v205
    v_mfma_f32_32x32x16_bf16 v[128:143], a[224:227], v[48:51], v[128:143]
    ds_read_b64_tr_b16 a[192:193], v204 offset:0
    ds_read_b64_tr_b16 a[194:195], v204 offset:512
    ds_read_b64 v[254:255], v194 offset:256
    ds_read_b64 v[252:253], v194 offset:512
    v_mfma_f32_32x32x16_bf16 v[144:159], a[228:231], v[48:51], v[144:159]
    ds_read_b64_tr_b16 a[196:197], v205 offset:0
    ds_read_b64_tr_b16 a[198:199], v205 offset:512
    s_add_u32 s25, s17, 204800
    buffer_load_dwordx4 a[100:103], v206, s[60:63], s25 offen offset:0 sc1
    ds_read_b64 v[250:251], v194 offset:768
    ds_read_b64 v[198:199], v194 offset:1024
    v_mfma_f32_32x32x16_bf16 v[128:143], a[232:235], v[52:55], v[128:143]
    ds_read_b64_tr_b16 a[200:201], v204 offset:2048
    ds_read_b64_tr_b16 a[202:203], v204 offset:2560
    ds_read_b64 v[196:197], v194 offset:1280
    ds_read_b64 v[202:203], v194 offset:1536
    ds_read_b64 v[200:201], v194 offset:1792
    v_accvgpr_read_b32 v243, a178
    v_accvgpr_read_b32 v0, a179
    v_accvgpr_read_b32 v1, a180
    v_accvgpr_read_b32 v244, a181
    v_mfma_f32_32x32x16_bf16 v[144:159], a[236:239], v[52:55], v[144:159]
    s_waitcnt lgkmcnt(13)
    ds_read_b64_tr_b16 a[204:205], v205 offset:2048
    ds_read_b64_tr_b16 a[206:207], v205 offset:2560
    buffer_load_dwordx4 a[104:107], v206, s[60:63], s24 offen offset:1024 sc1
    s_waitcnt lgkmcnt(2)
    v_fma_f32 v252, v216, v254, v252
    v_mfma_f32_32x32x16_bf16 v[128:143], a[240:243], v[56:59], v[128:143]
    ds_read_b64_tr_b16 a[208:209], v204 offset:4096
    ds_read_b64_tr_b16 a[210:211], v204 offset:4608
    v_fma_f32 v253, v216, v255, v253
    v_fma_f32 v252, -v217, v255, v252
    v_fmac_f32 v253, v217, v254
    v_fma_f32 v250, v216, v252, v250
    v_fma_f32 v251, v216, v253, v251
    v_fma_f32 v250, -v217, v253, v250
    v_fmac_f32 v251, v217, v252
    v_mfma_f32_32x32x16_bf16 v[144:159], a[244:247], v[56:59], v[144:159]
    ds_read_b64_tr_b16 a[212:213], v205 offset:4096
    ds_read_b64_tr_b16 a[214:215], v205 offset:4608
    buffer_load_dwordx4 a[108:111], v206, s[60:63], s25 offen offset:1024 sc1
    v_fma_f32 v198, v216, v250, v198
    v_fma_f32 v199, v216, v251, v199
    v_fma_f32 v198, -v217, v251, v198
    v_fmac_f32 v199, v217, v250
    v_mfma_f32_32x32x16_bf16 v[128:143], a[248:251], v[60:63], v[128:143]
    ds_read_b64_tr_b16 a[216:217], v204 offset:6144
    ds_read_b64_tr_b16 a[218:219], v204 offset:6656
    v_fma_f32 v196, v216, v198, v196
    v_fma_f32 v197, v216, v199, v197
    v_fma_f32 v196, -v217, v199, v196
    v_fmac_f32 v197, v217, v198
    v_fma_f32 v202, v216, v196, v202
    v_fma_f32 v203, v216, v197, v203
    v_mfma_f32_32x32x16_bf16 v[144:159], a[252:255], v[60:63], v[144:159]
    s_waitcnt lgkmcnt(6)
    ds_read_b64_tr_b16 a[220:221], v205 offset:6144
    ds_read_b64_tr_b16 a[222:223], v205 offset:6656
    s_add_u32 s24, s17, 28672
    buffer_load_dwordx4 a[112:115], v206, s[60:63], s24 offen offset:0 sc1
    v_fma_f32 v202, -v217, v197, v202
    v_fmac_f32 v203, v217, v196
    v_mfma_f32_32x32x16_bf16 v[128:143], a[192:195], v[64:67], v[128:143]
    ds_read_b64_tr_b16 a[224:225], v204 offset:8192
    ds_read_b64_tr_b16 a[226:227], v204 offset:8704
    v_fma_f32 v224, v216, v202, v200
    v_fma_f32 v225, v216, v203, v201
    v_fma_f32 v224, -v217, v203, v224
    v_fmac_f32 v225, v217, v202
    v_fma_f32 v246, v216, v224, v246
    v_fma_f32 v247, v216, v225, v247
    v_mfma_f32_32x32x16_bf16 v[144:159], a[196:199], v[64:67], v[144:159]
    ds_read_b64_tr_b16 a[228:229], v205 offset:8192
    ds_read_b64_tr_b16 a[230:231], v205 offset:8704
    s_add_u32 s25, s17, 208896
    buffer_load_dwordx4 a[116:119], v206, s[60:63], s25 offen offset:0 sc1
    v_fma_f32 v246, -v217, v225, v246
    v_fmac_f32 v247, v217, v224
    s_cmp_lg_u32 s88, 3
    s_cbranch_scc1 L_noe
    buffer_store_dwordx2 v[246:247], v244, s[84:87], 0 offen sc1
L_noe:
    v_mfma_f32_32x32x16_bf16 v[128:143], a[200:203], v[68:71], v[128:143]
    ds_read_b64_tr_b16 a[232:233], v204 offset:10240
    ds_read_b64_tr_b16 a[234:235], v204 offset:10752
    s_add_u32 m0, s32, 0
    s_add_u32 s94, s33, 0
    buffer_load_dwordx4 v243, s[40:43], s94 offen lds
    v_mfma_f32_32x32x16_bf16 v[144:159], a[204:207], v[68:71], v[144:159]
    s_waitcnt lgkmcnt(6)
    ds_read_b64_tr_b16 a[236:237], v205 offset:10240
    ds_read_b64_tr_b16 a[238:239], v205 offset:10752
    buffer_load_dwordx4 a[120:123], v206, s[60:63], s24 offen offset:1024 sc1
    v_mfma_f32_32x32x16_bf16 v[128:143], a[208:211], v[72:75], v[128:143]
    ds_read_b64_tr_b16 a[240:241], v204 offset:12288
    ds_read_b64_tr_b16 a[242:243], v204 offset:12800
    s_add_u32 m0, s32, 1024
    s_add_u32 s94, s33, 32768
    buffer_load_dwordx4 v243, s[40:43], s94 offen lds
    v_mfma_f32_32x32x16_bf16 v[144:159], a[212:215], v[72:75], v[144:159]
    ds_read_b64_tr_b16 a[244:245], v205 offset:12288
    ds_read_b64_tr_b16 a[246:247], v205 offset:12800
    buffer_load_dwordx4 a[124:127], v206, s[60:63], s25 offen offset:1024 sc1
    s_add_u32 m0, s32, 2048
    s_add_u32 s97, s99, 16384
    v_mfma_f32_32x32x16_bf16 v[128:143], a[216:219], v[76:79], v[128:143]
    ds_read_b64_tr_b16 a[248:249], v204 offset:14336
    ds_read_b64_tr_b16 a[250:251], v204 offset:14848
    global_load_lds_dwordx4 v[0:1], off
    v_mfma_f32_32x32x16_bf16 v[144:159], a[220:223], v[76:79], v[144:159]
    s_waitcnt lgkmcnt(6)
    ds_read_b64_tr_b16 a[252:253], v205 offset:14336
    ds_read_b64_tr_b16 a[254:255], v205 offset:14848
    s_add_u32 s24, s17, 32768
    buffer_load_dwordx4 a[128:131], v206, s[60:63], s24 offen offset:0 sc1
    v_mfma_f32_32x32x16_bf16 v[128:143], a[224:227], v[80:83], v[128:143]
    ds_read_b64_tr_b16 a[192:193], v204 offset:16384
    ds_read_b64_tr_b16 a[194:195], v204 offset:16896
    v_mfma_f32_32x32x16_bf16 v[144:159], a[228:231], v[80:83], v[144:159]
    ds_read_b64_tr_b16 a[196:197], v205 offset:16384
    ds_read_b64_tr_b16 a[198:199], v205 offset:16896
    s_add_u32 s25, s17, 212992
    buffer_load_dwordx4 a[132:135], v206, s[60:63], s25 offen offset:0 sc1
    v_mfma_f32_32x32x16_bf16 v[128:143], a[232:235], v[84:87], v[128:143]
    ds_read_b64_tr_b16 a[200:201], v204 offset:18432
    ds_read_b64_tr_b16 a[202:203], v204 offset:18944
    v_mfma_f32_32x32x16_bf16 v[144:159], a[236:239], v[84:87], v[144:159]
    s_waitcnt lgkmcnt(6)
    ds_read_b64_tr_b16 a[204:205], v205 offset:18432
    ds_read_b64_tr_b16 a[206:207], v205 offset:18944
    buffer_load_dwordx4 a[136:139], v206, s[60:63], s24 offen offset:1024 sc1
    v_mfma_f32_32x32x16_bf16 v[128:143], a[240:243], v[88:91], v[128:143]
    ds_read_b64_tr_b16 a[208:209], v204 offset:20480
    ds_read_b64_tr_b16 a[210:211], v204 offset:20992
    s_load_dwordx16 s[44:59], s[8:9], 0 glc
    v_mfma_f32_32x32x16_bf16 v[144:159], a[244:247], v[88:91], v[144:159]
    ds_read_b64_tr_b16 a[212:213], v205 offset:20480
    ds_read_b64_tr_b16 a[214:215], v205 offset:20992
    buffer_load_dwordx4 a[140:143], v206, s[60:63], s25 offen offset:1024 sc1
    v_mfma_f32_32x32x16_bf16 v[128:143], a[248:251], v[92:95], v[128:143]
    ds_read_b64_tr_b16 a[216:217], v204 offset:22528
    ds_read_b64_tr_b16 a[218:219], v204 offset:23040
    v_mfma_f32_32x32x16_bf16 v[144:159], a[252:255], v[92:95], v[144:159]
    s_waitcnt lgkmcnt(6)
    ds_read_b64_tr_b16 a[220:221], v205 offset:22528
    ds_read_b64_tr_b16 a[222:223], v205 offset:23040
    s_add_u32 s24, s17, 36864
    buffer_load_dwordx4 a[144:147], v206, s[60:63], s24 offen offset:0 sc1
    v_mfma_f32_32x32x16_bf16 v[128:143], a[192:195], v[96:99], v[128:143]
    ds_read_b64_tr_b16 a[224:225], v204 offset:24576
    ds_read_b64_tr_b16 a[226:227], v204 offset:25088
    v_mfma_f32_32x32x16_bf16 v[144:159], a[196:199], v[96:99], v[144:159]
    ds_read_b64_tr_b16 a[228:229], v205 offset:24576
    ds_read_b64_tr_b16 a[230:231], v205 offset:25088
    s_add_u32 s25, s17, 217088
    buffer_load_dwordx4 a[148:151], v206, s[60:63], s25 offen offset:0 sc1
    v_mfma_f32_32x32x16_bf16 v[128:143], a[200:203], v[100:103], v[128:143]
    ds_read_b64_tr_b16 a[232:233], v204 offset:26624
    ds_read_b64_tr_b16 a[234:235], v204 offset:27136
    v_mfma_f32_32x32x16_bf16 v[144:159], a[204:207], v[100:103], v[144:159]
    s_waitcnt lgkmcnt(6)
    ds_read_b64_tr_b16 a[236:237], v205 offset:26624
    ds_read_b64_tr_b16 a[238:239], v205 offset:27136
    buffer_load_dwordx4 a[152:155], v206, s[60:63], s24 offen offset:1024 sc1
    v_mfma_f32_32x32x16_bf16 v[128:143], a[208:211], v[104:107], v[128:143]
    ds_read_b64_tr_b16 a[240:241], v204 offset:28672
    ds_read_b64_tr_b16 a[242:243], v204 offset:29184
    v_mfma_f32_32x32x16_bf16 v[144:159], a[212:215], v[104:107], v[144:159]
    ds_read_b64_tr_b16 a[244:245], v205 offset:28672
    ds_read_b64_tr_b16 a[246:247], v205 offset:29184
    buffer_load_dwordx4 a[156:159], v206, s[60:63], s25 offen offset:1024 sc1
    v_mfma_f32_32x32x16_bf16 v[128:143], a[216:219], v[108:111], v[128:143]
    ds_read_b64_tr_b16 a[248:249], v204 offset:30720
    ds_read_b64_tr_b16 a[250:251], v204 offset:31232
    v_mfma_f32_32x32x16_bf16 v[144:159], a[220:223], v[108:111], v[144:159]
    s_waitcnt lgkmcnt(6)
    ds_read_b64_tr_b16 a[252:253], v205 offset:30720
    ds_read_b64_tr_b16 a[254:255], v205 offset:31232
    s_add_u32 s24, s17, 40960
    buffer_load_dwordx4 a[160:163], v206, s[60:63], s24 offen offset:0 sc1
    v_mfma_f32_32x32x16_bf16 v[128:143], a[224:227], v[112:115], v[128:143]
    v_mfma_f32_32x32x16_bf16 v[144:159], a[228:231], v[112:115], v[144:159]
    s_add_u32 s25, s17, 221184
    buffer_load_dwordx4 a[164:167], v206, s[60:63], s25 offen offset:0 sc1
    v_mfma_f32_32x32x16_bf16 v[128:143], a[232:235], v[116:119], v[128:143]
    v_mfma_f32_32x32x16_bf16 v[144:159], a[236:239], v[116:119], v[144:159]
    s_waitcnt lgkmcnt(0)
    buffer_load_dwordx4 a[168:171], v206, s[60:63], s24 offen offset:1024 sc1
    v_mfma_f32_32x32x16_bf16 v[128:143], a[240:243], v[120:123], v[128:143]
    v_mfma_f32_32x32x16_bf16 v[144:159], a[244:247], v[120:123], v[144:159]
    buffer_load_dwordx4 a[172:175], v206, s[60:63], s25 offen offset:1024 sc1
    v_mfma_f32_32x32x16_bf16 v[128:143], a[248:251], v[124:127], v[128:143]
    v_mfma_f32_32x32x16_bf16 v[144:159], a[252:255], v[124:127], v[144:159]
    s_cmp_eq_u32 s91, 3
    s_cselect_b64 vcc, -1, 0
    s_lshl2_add_u32 s95, s88, s89
    s_lshl_b32 s95, s95, 8
    s_sub_u32 s95, s95, 4096
    v_add_u32 v48, s95, v206
    s_lshl_b32 s94, s88, 10
    s_add_u32 s94, s94, 110592
    v_add_u32 v53, s94, v206
    v_accvgpr_read_b32 v52, a182
    v_accvgpr_read_b32 v50, a176
    v_accvgpr_read_b32 v51, a177
    s_cbranch_vccnz L_q0
    v_pk_mul_f32 v[250:251], v[128:129], v[128:129]
    v_pk_mul_f32 v[252:253], v[130:131], v[130:131]
    v_pk_fma_f32 v[250:251], v[250:251], v[210:211], v[210:211] op_sel:[0,1,0] op_sel_hi:[1,1,0]
    v_pk_fma_f32 v[252:253], v[252:253], v[210:211], v[210:211] op_sel:[0,1,0] op_sel_hi:[1,1,0]
    v_pk_mul_f32 v[250:251], v[250:251], v[128:129]
    v_pk_mul_f32 v[252:253], v[252:253], v[130:131]
    v_exp_f32 v250, v250
    v_exp_f32 v251, v251
    v_exp_f32 v252, v252
    v_exp_f32 v253, v253
    v_pk_fma_f32 v[250:251], v[250:251], v[208:209], v[208:209] op_sel:[0,1,1] op_sel_hi:[1,1,1]
    v_pk_fma_f32 v[252:253], v[252:253], v[208:209], v[208:209] op_sel:[0,1,1] op_sel_hi:[1,1,1]
    v_rcp_f32 v250, v250
    v_rcp_f32 v251, v251
    v_rcp_f32 v252, v252
    v_rcp_f32 v253, v253
    v_pk_mul_f32 v[128:129], v[128:129], v[250:251]
    v_pk_mul_f32 v[130:131], v[130:131], v[252:253]
L_q0:
    s_mov_b32 s96, 0
L_hf0:
    s_waitcnt lgkmcnt(0)
    s_and_b64 s[44:45], s[44:45], s[46:47]
    s_and_b64 s[44:45], s[44:45], s[48:49]
    s_and_b64 s[44:45], s[44:45], s[50:51]
    s_and_b64 s[44:45], s[44:45], s[52:53]
    s_and_b64 s[44:45], s[44:45], s[54:55]
    s_and_b64 s[44:45], s[44:45], s[56:57]
    s_and_b64 s[44:45], s[44:45], s[58:59]
    s_and_b32 s44, s44, s45
    s_cbranch_scc1 L_hf0_done
    s_add_u32 s96, s96, 1
    s_cmp_ge_u32 s96, 100000
    s_cbranch_scc1 L_hf0_done
    s_load_dwordx16 s[44:59], s[8:9], 0 glc
    s_branch L_hf0
L_hf0_done:
    s_add_u32 s24, s18, 0
    buffer_load_dwordx4 a[192:195], v206, s[60:63], s24 offen offset:0 sc1
    buffer_load_dwordx4 v[56:59], v48, s[84:87], 0 offen sc1
    s_cbranch_vccnz L_q1
    v_pk_mul_f32 v[250:251], v[132:133], v[132:133]
    v_pk_mul_f32 v[252:253], v[134:135], v[134:135]
    v_pk_fma_f32 v[250:251], v[250:251], v[210:211], v[210:211] op_sel:[0,1,0] op_sel_hi:[1,1,0]
    v_pk_fma_f32 v[252:253], v[252:253], v[210:211], v[210:211] op_sel:[0,1,0] op_sel_hi:[1,1,0]
    v_pk_mul_f32 v[250:251], v[250:251], v[132:133]
    v_pk_mul_f32 v[252:253], v[252:253], v[134:135]
    v_exp_f32 v250, v250
    v_exp_f32 v251, v251
    v_exp_f32 v252, v252
    v_exp_f32 v253, v253
    v_pk_fma_f32 v[250:251], v[250:251], v[208:209], v[208:209] op_sel:[0,1,1] op_sel_hi:[1,1,1]
    v_pk_fma_f32 v[252:253], v[252:253], v[208:209], v[208:209] op_sel:[0,1,1] op_sel_hi:[1,1,1]
    v_rcp_f32 v250, v250
    v_rcp_f32 v251, v251
    v_rcp_f32 v252, v252
    v_rcp_f32 v253, v253
    v_pk_mul_f32 v[132:133], v[132:133], v[250:251]
    v_pk_mul_f32 v[134:135], v[134:135], v[252:253]
    v_cvt_pk_bf16_f32 v128, v128, v129
    v_cvt_pk_bf16_f32 v129, v130, v131
    v_cvt_pk_bf16_f32 v130, v132, v133
    v_cvt_pk_bf16_f32 v131, v134, v135
L_q1:
    buffer_store_dwordx4 v[128:131], v206, s[64:67], s97 offen offset:0 sc1
    buffer_load_dwordx4 a[196:199], v206, s[60:63], s24 offen offset:1024 sc1
    s_add_u32 s24, s18, 180224
    buffer_load_dwordx4 a[200:203], v206, s[60:63], s24 offen offset:0 sc1
    s_cbranch_vccnz L_q2
    v_pk_mul_f32 v[250:251], v[136:137], v[136:137]
    v_pk_mul_f32 v[252:253], v[138:139], v[138:139]
    v_pk_fma_f32 v[250:251], v[250:251], v[210:211], v[210:211] op_sel:[0,1,0] op_sel_hi:[1,1,0]
    v_pk_fma_f32 v[252:253], v[252:253], v[210:211], v[210:211] op_sel:[0,1,0] op_sel_hi:[1,1,0]
    v_pk_mul_f32 v[250:251], v[250:251], v[136:137]
    v_pk_mul_f32 v[252:253], v[252:253], v[138:139]
    v_exp_f32 v250, v250
    v_exp_f32 v251, v251
    v_exp_f32 v252, v252
    v_exp_f32 v253, v253
    v_pk_fma_f32 v[250:251], v[250:251], v[208:209], v[208:209] op_sel:[0,1,1] op_sel_hi:[1,1,1]
    v_pk_fma_f32 v[252:253], v[252:253], v[208:209], v[208:209] op_sel:[0,1,1] op_sel_hi:[1,1,1]
    v_rcp_f32 v250, v250
    v_rcp_f32 v251, v251
    v_rcp_f32 v252, v252
    v_rcp_f32 v253, v253
    v_pk_mul_f32 v[136:137], v[136:137], v[250:251]
    v_pk_mul_f32 v[138:139], v[138:139], v[252:253]
L_q2:
    buffer_load_dwordx4 a[204:207], v206, s[60:63], s24 offen offset:1024 sc1
    s_add_u32 s24, s6, 0
    buffer_load_dwordx4 a[208:211], v206, s[60:63], s24 offen offset:0 sc1
    s_cbranch_vccnz L_q3
    v_pk_mul_f32 v[250:251], v[140:141], v[140:141]
    v_pk_mul_f32 v[252:253], v[142:143], v[142:143]
    v_pk_fma_f32 v[250:251], v[250:251], v[210:211], v[210:211] op_sel:[0,1,0] op_sel_hi:[1,1,0]
    v_pk_fma_f32 v[252:253], v[252:253], v[210:211], v[210:211] op_sel:[0,1,0] op_sel_hi:[1,1,0]
    v_pk_mul_f32 v[250:251], v[250:251], v[140:141]
    v_pk_mul_f32 v[252:253], v[252:253], v[142:143]
    v_exp_f32 v250, v250
    v_exp_f32 v251, v251
    v_exp_f32 v252, v252
    v_exp_f32 v253, v253
    v_pk_fma_f32 v[250:251], v[250:251], v[208:209], v[208:209] op_sel:[0,1,1] op_sel_hi:[1,1,1]
    v_pk_fma_f32 v[252:253], v[252:253], v[208:209], v[208:209] op_sel:[0,1,1] op_sel_hi:[1,1,1]
    v_rcp_f32 v250, v250
    v_rcp_f32 v251, v251
    v_rcp_f32 v252, v252
    v_rcp_f32 v253, v253
    v_pk_mul_f32 v[140:141], v[140:141], v[250:251]
    v_pk_mul_f32 v[142:143], v[142:143], v[252:253]
    v_cvt_pk_bf16_f32 v136, v136, v137
    v_cvt_pk_bf16_f32 v137, v138, v139
    v_cvt_pk_bf16_f32 v138, v140, v141
    v_cvt_pk_bf16_f32 v139, v142, v143
L_q3:
    buffer_store_dwordx4 v[136:139], v206, s[64:67], s97 offen offset:1024 sc1
    buffer_load_dwordx4 a[212:215], v206, s[60:63], s24 offen offset:1024 sc1
    s_cbranch_vccnz L_q4
    v_pk_mul_f32 v[250:251], v[144:145], v[144:145]
    v_pk_mul_f32 v[252:253], v[146:147], v[146:147]
    v_pk_fma_f32 v[250:251], v[250:251], v[210:211], v[210:211] op_sel:[0,1,0] op_sel_hi:[1,1,0]
    v_pk_fma_f32 v[252:253], v[252:253], v[210:211], v[210:211] op_sel:[0,1,0] op_sel_hi:[1,1,0]
    v_pk_mul_f32 v[250:251], v[250:251], v[144:145]
    v_pk_mul_f32 v[252:253], v[252:253], v[146:147]
    v_exp_f32 v250, v250
    v_exp_f32 v251, v251
    v_exp_f32 v252, v252
    v_exp_f32 v253, v253
    v_pk_fma_f32 v[250:251], v[250:251], v[208:209], v[208:209] op_sel:[0,1,1] op_sel_hi:[1,1,1]
    v_pk_fma_f32 v[252:253], v[252:253], v[208:209], v[208:209] op_sel:[0,1,1] op_sel_hi:[1,1,1]
    v_rcp_f32 v250, v250
    v_rcp_f32 v251, v251
    v_rcp_f32 v252, v252
    v_rcp_f32 v253, v253
    v_pk_mul_f32 v[144:145], v[144:145], v[250:251]
    v_pk_mul_f32 v[146:147], v[146:147], v[252:253]
L_q4:
    s_add_u32 s24, s6, 180224
    buffer_load_dwordx4 a[216:219], v206, s[60:63], s24 offen offset:0 sc1
    buffer_load_dwordx4 a[220:223], v206, s[60:63], s24 offen offset:1024 sc1
    s_cbranch_vccnz L_q5
    v_pk_mul_f32 v[250:251], v[148:149], v[148:149]
    v_pk_mul_f32 v[252:253], v[150:151], v[150:151]
    v_pk_fma_f32 v[250:251], v[250:251], v[210:211], v[210:211] op_sel:[0,1,0] op_sel_hi:[1,1,0]
    v_pk_fma_f32 v[252:253], v[252:253], v[210:211], v[210:211] op_sel:[0,1,0] op_sel_hi:[1,1,0]
    v_pk_mul_f32 v[250:251], v[250:251], v[148:149]
    v_pk_mul_f32 v[252:253], v[252:253], v[150:151]
    v_exp_f32 v250, v250
    v_exp_f32 v251, v251
    v_exp_f32 v252, v252
    v_exp_f32 v253, v253
    v_pk_fma_f32 v[250:251], v[250:251], v[208:209], v[208:209] op_sel:[0,1,1] op_sel_hi:[1,1,1]
    v_pk_fma_f32 v[252:253], v[252:253], v[208:209], v[208:209] op_sel:[0,1,1] op_sel_hi:[1,1,1]
    v_rcp_f32 v250, v250
    v_rcp_f32 v251, v251
    v_rcp_f32 v252, v252
    v_rcp_f32 v253, v253
    v_pk_mul_f32 v[148:149], v[148:149], v[250:251]
    v_pk_mul_f32 v[150:151], v[150:151], v[252:253]
    v_cvt_pk_bf16_f32 v144, v144, v145
    v_cvt_pk_bf16_f32 v145, v146, v147
    v_cvt_pk_bf16_f32 v146, v148, v149
    v_cvt_pk_bf16_f32 v147, v150, v151
L_q5:
    buffer_store_dwordx4 v[144:147], v206, s[64:67], s97 offen offset:2048 sc1
    s_add_u32 s24, s18, 4096
    buffer_load_dwordx4 a[224:227], v206, s[60:63], s24 offen offset:0 sc1
    buffer_load_dwordx4 a[228:231], v206, s[60:63], s24 offen offset:1024 sc1
    s_cbranch_vccnz L_q6
    v_pk_mul_f32 v[250:251], v[152:153], v[152:153]
    v_pk_mul_f32 v[252:253], v[154:155], v[154:155]
    v_pk_fma_f32 v[250:251], v[250:251], v[210:211], v[210:211] op_sel:[0,1,0] op_sel_hi:[1,1,0]
    v_pk_fma_f32 v[252:253], v[252:253], v[210:211], v[210:211] op_sel:[0,1,0] op_sel_hi:[1,1,0]
    v_pk_mul_f32 v[250:251], v[250:251], v[152:153]
    v_pk_mul_f32 v[252:253], v[252:253], v[154:155]
    v_exp_f32 v250, v250
    v_exp_f32 v251, v251
    v_exp_f32 v252, v252
    v_exp_f32 v253, v253
    v_pk_fma_f32 v[250:251], v[250:251], v[208:209], v[208:209] op_sel:[0,1,1] op_sel_hi:[1,1,1]
    v_pk_fma_f32 v[252:253], v[252:253], v[208:209], v[208:209] op_sel:[0,1,1] op_sel_hi:[1,1,1]
    v_rcp_f32 v250, v250
    v_rcp_f32 v251, v251
    v_rcp_f32 v252, v252
    v_rcp_f32 v253, v253
    v_pk_mul_f32 v[152:153], v[152:153], v[250:251]
    v_pk_mul_f32 v[154:155], v[154:155], v[252:253]
L_q6:
    s_add_u32 s24, s18, 184320
    buffer_load_dwordx4 a[232:235], v206, s[60:63], s24 offen offset:0 sc1
    buffer_load_dwordx4 a[236:239], v206, s[60:63], s24 offen offset:1024 sc1
    s_cbranch_vccnz L_q7
    v_pk_mul_f32 v[250:251], v[156:157], v[156:157]
    v_pk_mul_f32 v[252:253], v[158:159], v[158:159]
    v_pk_fma_f32 v[250:251], v[250:251], v[210:211], v[210:211] op_sel:[0,1,0] op_sel_hi:[1,1,0]
    v_pk_fma_f32 v[252:253], v[252:253], v[210:211], v[210:211] op_sel:[0,1,0] op_sel_hi:[1,1,0]
    v_pk_mul_f32 v[250:251], v[250:251], v[156:157]
    v_pk_mul_f32 v[252:253], v[252:253], v[158:159]
    v_exp_f32 v250, v250
    v_exp_f32 v251, v251
    v_exp_f32 v252, v252
    v_exp_f32 v253, v253
    v_pk_fma_f32 v[250:251], v[250:251], v[208:209], v[208:209] op_sel:[0,1,1] op_sel_hi:[1,1,1]
    v_pk_fma_f32 v[252:253], v[252:253], v[208:209], v[208:209] op_sel:[0,1,1] op_sel_hi:[1,1,1]
    v_rcp_f32 v250, v250
    v_rcp_f32 v251, v251
    v_rcp_f32 v252, v252
    v_rcp_f32 v253, v253
    v_pk_mul_f32 v[156:157], v[156:157], v[250:251]
    v_pk_mul_f32 v[158:159], v[158:159], v[252:253]
    v_cvt_pk_bf16_f32 v152, v152, v153
    v_cvt_pk_bf16_f32 v153, v154, v155
    v_cvt_pk_bf16_f32 v154, v156, v157
    v_cvt_pk_bf16_f32 v155, v158, v159
L_q7:
    buffer_store_dwordx4 v[152:155], v206, s[64:67], s97 offen offset:3072 sc1
    s_waitcnt vmcnt(15)
    s_mov_b32 s96, 0
L_epoll:
    v_max3_u32 v49, v56, v57, v58
    v_max_u32 v49, v49, v59
    v_cmp_eq_u32 vcc, -1, v49
    s_nop 1
    s_cmp_eq_u64 vcc, 0
    s_cbranch_scc1 L_epoll_done
    s_add_u32 s96, s96, 1
    s_cmp_ge_u32 s96, 100000
    s_cbranch_scc1 L_epoll_done
    buffer_load_dwordx4 v[56:59], v48, s[84:87], 0 offen sc1
    s_waitcnt vmcnt(0)
    s_branch L_epoll
L_epoll_done:
    ds_write_b128 v53, v[56:59]
    v_pk_mul_f32 v[64:65], v[214:215], v[160:161] op_sel:[0,0] op_sel_hi:[1,0]
    v_pk_fma_f32 v[64:65], v[214:215], v[176:177], v[64:65] op_sel:[1,0,0] op_sel_hi:[0,0,1] neg_lo:[1,0,0]
    v_pk_mul_f32 v[66:67], v[214:215], v[160:161] op_sel:[0,1] op_sel_hi:[1,1]
    v_pk_fma_f32 v[66:67], v[214:215], v[176:177], v[66:67] op_sel:[1,1,0] op_sel_hi:[0,1,1] neg_lo:[1,0,0]
    v_pk_mul_f32 v[68:69], v[214:215], v[162:163] op_sel:[0,0] op_sel_hi:[1,0]
    v_pk_fma_f32 v[68:69], v[214:215], v[178:179], v[68:69] op_sel:[1,0,0] op_sel_hi:[0,0,1] neg_lo:[1,0,0]
    v_pk_mul_f32 v[70:71], v[214:215], v[162:163] op_sel:[0,1] op_sel_hi:[1,1]
    v_pk_fma_f32 v[70:71], v[214:215], v[178:179], v[70:71] op_sel:[1,1,0] op_sel_hi:[0,1,1] neg_lo:[1,0,0]
    v_pk_mul_f32 v[72:73], v[214:215], v[164:165] op_sel:[0,0] op_sel_hi:[1,0]
    v_pk_fma_f32 v[72:73], v[214:215], v[180:181], v[72:73] op_sel:[1,0,0] op_sel_hi:[0,0,1] neg_lo:[1,0,0]
    v_pk_mul_f32 v[74:75], v[214:215], v[164:165] op_sel:[0,1] op_sel_hi:[1,1]
    v_pk_fma_f32 v[74:75], v[214:215], v[180:181], v[74:75] op_sel:[1,1,0] op_sel_hi:[0,1,1] neg_lo:[1,0,0]
    s_waitcnt lgkmcnt(0)
    s_barrier
    ds_read_b64 v[46:47], v52 offset:0
    ds_read_b64 v[44:45], v52 offset:512
    ds_read_b64 v[42:43], v52 offset:1024
    ds_read_b64 v[40:41], v52 offset:1536
    ds_read_b64 v[38:39], v52 offset:2048
    ds_read_b64 v[36:37], v52 offset:2560
    ds_read_b64 v[34:35], v52 offset:3072
    ds_read_b64 v[32:33], v52 offset:3584
    v_pk_mul_f32 v[76:77], v[214:215], v[166:167] op_sel:[0,0] op_sel_hi:[1,0]
    v_pk_fma_f32 v[76:77], v[214:215], v[182:183], v[76:77] op_sel:[1,0,0] op_sel_hi:[0,0,1] neg_lo:[1,0,0]
    v_pk_mul_f32 v[78:79], v[214:215], v[166:167] op_sel:[0,1] op_sel_hi:[1,1]
    v_pk_fma_f32 v[78:79], v[214:215], v[182:183], v[78:79] op_sel:[1,1,0] op_sel_hi:[0,1,1] neg_lo:[1,0,0]
    v_pk_mul_f32 v[80:81], v[214:215], v[168:169] op_sel:[0,0] op_sel_hi:[1,0]
    v_pk_fma_f32 v[80:81], v[214:215], v[184:185], v[80:81] op_sel:[1,0,0] op_sel_hi:[0,0,1] neg_lo:[1,0,0]
    v_pk_mul_f32 v[82:83], v[214:215], v[168:169] op_sel:[0,1] op_sel_hi:[1,1]
    v_pk_fma_f32 v[82:83], v[214:215], v[184:185], v[82:83] op_sel:[1,1,0] op_sel_hi:[0,1,1] neg_lo:[1,0,0]
    v_pk_mul_f32 v[84:85], v[214:215], v[170:171] op_sel:[0,0] op_sel_hi:[1,0]
    v_pk_fma_f32 v[84:85], v[214:215], v[186:187], v[84:85] op_sel:[1,0,0] op_sel_hi:[0,0,1] neg_lo:[1,0,0]
    v_pk_mul_f32 v[86:87], v[214:215], v[170:171] op_sel:[0,1] op_sel_hi:[1,1]
    v_pk_fma_f32 v[86:87], v[214:215], v[186:187], v[86:87] op_sel:[1,1,0] op_sel_hi:[0,1,1] neg_lo:[1,0,0]
    v_pk_mul_f32 v[88:89], v[214:215], v[172:173] op_sel:[0,0] op_sel_hi:[1,0]
    v_pk_fma_f32 v[88:89], v[214:215], v[188:189], v[88:89] op_sel:[1,0,0] op_sel_hi:[0,0,1] neg_lo:[1,0,0]
    v_pk_mul_f32 v[90:91], v[214:215], v[172:173] op_sel:[0,1] op_sel_hi:[1,1]
    v_pk_fma_f32 v[90:91], v[214:215], v[188:189], v[90:91] op_sel:[1,1,0] op_sel_hi:[0,1,1] neg_lo:[1,0,0]
    v_pk_mul_f32 v[92:93], v[214:215], v[174:175] op_sel:[0,0] op_sel_hi:[1,0]
    v_pk_fma_f32 v[92:93], v[214:215], v[190:191], v[92:93] op_sel:[1,0,0] op_sel_hi:[0,0,1] neg_lo:[1,0,0]
    v_pk_mul_f32 v[94:95], v[214:215], v[174:175] op_sel:[0,1] op_sel_hi:[1,1]
    v_pk_fma_f32 v[94:95], v[214:215], v[190:191], v[94:95] op_sel:[1,1,0] op_sel_hi:[0,1,1] neg_lo:[1,0,0]
    s_waitcnt lgkmcnt(0)
    v_pk_fma_f32 v[44:45], v[46:47], v[222:223], v[44:45] op_sel:[0,0,0] op_sel_hi:[1,0,1]
    v_pk_fma_f32 v[44:45], v[46:47], v[222:223], v[44:45] op_sel:[1,1,0] op_sel_hi:[0,1,1] neg_lo:[0,1,0]
    v_pk_fma_f32 v[42:43], v[44:45], v[222:223], v[42:43] op_sel:[0,0,0] op_sel_hi:[1,0,1]
    v_pk_fma_f32 v[42:43], v[44:45], v[222:223], v[42:43] op_sel:[1,1,0] op_sel_hi:[0,1,1] neg_lo:[0,1,0]
    v_pk_fma_f32 v[40:41], v[42:43], v[222:223], v[40:41] op_sel:[0,0,0] op_sel_hi:[1,0,1]
    v_pk_fma_f32 v[40:41], v[42:43], v[222:223], v[40:41] op_sel:[1,1,0] op_sel_hi:[0,1,1] neg_lo:[0,1,0]
    v_pk_fma_f32 v[38:39], v[40:41], v[222:223], v[38:39] op_sel:[0,0,0] op_sel_hi:[1,0,1]
    v_pk_fma_f32 v[38:39], v[40:41], v[222:223], v[38:39] op_sel:[1,1,0] op_sel_hi:[0,1,1] neg_lo:[0,1,0]
    v_pk_fma_f32 v[36:37], v[38:39], v[222:223], v[36:37] op_sel:[0,0,0] op_sel_hi:[1,0,1]
    v_pk_fma_f32 v[36:37], v[38:39], v[222:223], v[36:37] op_sel:[1,1,0] op_sel_hi:[0,1,1] neg_lo:[0,1,0]
    v_pk_fma_f32 v[34:35], v[36:37], v[222:223], v[34:35] op_sel:[0,0,0] op_sel_hi:[1,0,1]
    v_pk_fma_f32 v[34:35], v[36:37], v[222:223], v[34:35] op_sel:[1,1,0] op_sel_hi:[0,1,1] neg_lo:[0,1,0]
    v_pk_fma_f32 v[32:33], v[34:35], v[222:223], v[32:33] op_sel:[0,0,0] op_sel_hi:[1,0,1]
    v_pk_fma_f32 v[32:33], v[34:35], v[222:223], v[32:33] op_sel:[1,1,0] op_sel_hi:[0,1,1] neg_lo:[0,1,0]
    v_pk_mul_f32 v[34:35], v[32:33], v[220:221] op_sel:[0,0] op_sel_hi:[1,0]
    v_pk_fma_f32 v[34:35], v[32:33], v[220:221], v[34:35] op_sel:[1,1,0] op_sel_hi:[0,1,1] neg_lo:[0,1,0]
    v_mov_b32 v36, v34
    v_mov_b32 v37, v35
    s_add_u32 s98, s99, 28672
    v_permlane32_swap_b32 v34, v36
    v_permlane32_swap_b32 v35, v37
    v_pk_add_f32 v[34:35], v[34:35], v[36:37]
    v_pk_fma_f32 v[224:225], v[34:35], v[218:219], v[224:225] op_sel:[0,0,0] op_sel_hi:[1,0,1]
    v_pk_fma_f32 v[224:225], v[34:35], v[218:219], v[224:225] op_sel:[1,1,0] op_sel_hi:[0,1,1] neg_lo:[0,1,0]
    v_pk_mul_f32 v[36:37], v[224:225], v[214:215] op_sel:[0,0] op_sel_hi:[1,0]
    v_pk_fma_f32 v[36:37], v[224:225], v[214:215], v[36:37] op_sel:[1,1,0] op_sel_hi:[0,1,1] neg_lo:[0,1,0]
    v_pk_fma_f32 v[64:65], v[36:37], v[212:213], v[64:65] op_sel:[0,0,0] op_sel_hi:[1,0,1]
    v_pk_fma_f32 v[64:65], v[36:37], v[212:213], v[64:65] op_sel:[1,1,0] op_sel_hi:[0,1,1] neg_lo:[0,1,0]
    v_pk_fma_f32 v[66:67], v[64:65], v[212:213], v[66:67] op_sel:[0,0,0] op_sel_hi:[1,0,1]
    v_pk_fma_f32 v[66:67], v[64:65], v[212:213], v[66:67] op_sel:[1,1,0] op_sel_hi:[0,1,1] neg_lo:[0,1,0]
    v_cvt_pk_bf16_f32 v0, v64, v66
    v_cvt_pk_bf16_f32 v8, -v65, -v67
    v_pk_fma_f32 v[68:69], v[66:67], v[212:213], v[68:69] op_sel:[0,0,0] op_sel_hi:[1,0,1]
    v_pk_fma_f32 v[68:69], v[66:67], v[212:213], v[68:69] op_sel:[1,1,0] op_sel_hi:[0,1,1] neg_lo:[0,1,0]
    s_add_u32 s24, s6, 4096
    buffer_load_dwordx4 a[240:243], v206, s[60:63], s24 offen offset:0 sc1
    v_pk_fma_f32 v[70:71], v[68:69], v[212:213], v[70:71] op_sel:[0,0,0] op_sel_hi:[1,0,1]
    v_pk_fma_f32 v[70:71], v[68:69], v[212:213], v[70:71] op_sel:[1,1,0] op_sel_hi:[0,1,1] neg_lo:[0,1,0]
    v_cvt_pk_bf16_f32 v1, v68, v70
    v_cvt_pk_bf16_f32 v9, -v69, -v71
    v_pk_fma_f32 v[72:73], v[70:71], v[212:213], v[72:73] op_sel:[0,0,0] op_sel_hi:[1,0,1]
    v_pk_fma_f32 v[72:73], v[70:71], v[212:213], v[72:73] op_sel:[1,1,0] op_sel_hi:[0,1,1] neg_lo:[0,1,0]
    v_pk_fma_f32 v[74:75], v[72:73], v[212:213], v[74:75] op_sel:[0,0,0] op_sel_hi:[1,0,1]
    v_pk_fma_f32 v[74:75], v[72:73], v[212:213], v[74:75] op_sel:[1,1,0] op_sel_hi:[0,1,1] neg_lo:[0,1,0]
    v_cvt_pk_bf16_f32 v2, v72, v74
    v_cvt_pk_bf16_f32 v10, -v73, -v75
    v_pk_fma_f32 v[76:77], v[74:75], v[212:213], v[76:77] op_sel:[0,0,0] op_sel_hi:[1,0,1]
    v_pk_fma_f32 v[76:77], v[74:75], v[212:213], v[76:77] op_sel:[1,1,0] op_sel_hi:[0,1,1] neg_lo:[0,1,0]
    buffer_load_dwordx4 a[244:247], v206, s[60:63], s24 offen offset:1024 sc1
    v_pk_fma_f32 v[78:79], v[76:77], v[212:213], v[78:79] op_sel:[0,0,0] op_sel_hi:[1,0,1]
    v_pk_fma_f32 v[78:79], v[76:77], v[212:213], v[78:79] op_sel:[1,1,0] op_sel_hi:[0,1,1] neg_lo:[0,1,0]
    v_cvt_pk_bf16_f32 v3, v76, v78
    v_cvt_pk_bf16_f32 v11, -v77, -v79
    ds_write_b128 v50, v[0:3] offset:0
    ds_write_b128 v50, v[8:11] offset:2560
    v_pk_fma_f32 v[80:81], v[78:79], v[212:213], v[80:81] op_sel:[0,0,0] op_sel_hi:[1,0,1]
    v_pk_fma_f32 v[80:81], v[78:79], v[212:213], v[80:81] op_sel:[1,1,0] op_sel_hi:[0,1,1] neg_lo:[0,1,0]
    v_pk_fma_f32 v[82:83], v[80:81], v[212:213], v[82:83] op_sel:[0,0,0] op_sel_hi:[1,0,1]
    v_pk_fma_f32 v[82:83], v[80:81], v[212:213], v[82:83] op_sel:[1,1,0] op_sel_hi:[0,1,1] neg_lo:[0,1,0]
    v_cvt_pk_bf16_f32 v4, v80, v82
    v_cvt_pk_bf16_f32 v12, -v81, -v83
    v_pk_fma_f32 v[84:85], v[82:83], v[212:213], v[84:85] op_sel:[0,0,0] op_sel_hi:[1,0,1]
    v_pk_fma_f32 v[84:85], v[82:83], v[212:213], v[84:85] op_sel:[1,1,0] op_sel_hi:[0,1,1] neg_lo:[0,1,0]
    s_add_u32 s24, s6, 184320
    buffer_load_dwordx4 a[248:251], v206, s[60:63], s24 offen offset:0 sc1
    v_pk_fma_f32 v[86:87], v[84:85], v[212:213], v[86:87] op_sel:[0,0,0] op_sel_hi:[1,0,1]
    v_pk_fma_f32 v[86:87], v[84:85], v[212:213], v[86:87] op_sel:[1,1,0] op_sel_hi:[0,1,1] neg_lo:[0,1,0]
    v_cvt_pk_bf16_f32 v5, v84, v86
    v_cvt_pk_bf16_f32 v13, -v85, -v87
    v_pk_fma_f32 v[88:89], v[86:87], v[212:213], v[88:89] op_sel:[0,0,0] op_sel_hi:[1,0,1]
    v_pk_fma_f32 v[88:89], v[86:87], v[212:213], v[88:89] op_sel:[1,1,0] op_sel_hi:[0,1,1] neg_lo:[0,1,0]
    v_pk_fma_f32 v[90:91], v[88:89], v[212:213], v[90:91] op_sel:[0,0,0] op_sel_hi:[1,0,1]
    v_pk_fma_f32 v[90:91], v[88:89], v[212:213], v[90:91] op_sel:[1,1,0] op_sel_hi:[0,1,1] neg_lo:[0,1,0]
    v_cvt_pk_bf16_f32 v6, v88, v90
    v_cvt_pk_bf16_f32 v14, -v89, -v91
    v_pk_fma_f32 v[92:93], v[90:91], v[212:213], v[92:93] op_sel:[0,0,0] op_sel_hi:[1,0,1]
    v_pk_fma_f32 v[92:93], v[90:91], v[212:213], v[92:93] op_sel:[1,1,0] op_sel_hi:[0,1,1] neg_lo:[0,1,0]
    buffer_load_dwordx4 a[252:255], v206, s[60:63], s24 offen offset:1024 sc1
    v_pk_fma_f32 v[94:95], v[92:93], v[212:213], v[94:95] op_sel:[0,0,0] op_sel_hi:[1,0,1]
    v_pk_fma_f32 v[94:95], v[92:93], v[212:213], v[94:95] op_sel:[1,1,0] op_sel_hi:[0,1,1] neg_lo:[0,1,0]
    v_cvt_pk_bf16_f32 v7, v92, v94
    v_cvt_pk_bf16_f32 v15, -v93, -v95
    ds_write_b128 v50, v[4:7] offset:16
    ds_write_b128 v50, v[12:15] offset:2576
    ds_read_b64_tr_b16 v[16:17], v51 offset:0
    ds_read_b64_tr_b16 v[18:19], v51 offset:640
    ds_read_b64_tr_b16 v[20:21], v51 offset:320
    ds_read_b64_tr_b16 v[22:23], v51 offset:960
    ds_read_b64_tr_b16 v[24:25], v51 offset:2560
    ds_read_b64_tr_b16 v[26:27], v51 offset:3200
    ds_read_b64_tr_b16 v[28:29], v51 offset:2880
    ds_read_b64_tr_b16 v[30:31], v51 offset:3520
    s_waitcnt vmcnt(4)
    buffer_store_dword v240, v239, s[60:63], s29 offen offset:128 sc1
    s_waitcnt lgkmcnt(0)
    buffer_store_dwordx4 v[16:19], v206, s[60:63], s98 offen offset:0 sc1
    buffer_store_dwordx4 v[20:23], v206, s[60:63], s98 offen offset:1024 sc1
    buffer_store_dwordx4 v[24:27], v206, s[60:63], s98 offen offset:2048 sc1
    buffer_store_dwordx4 v[28:31], v206, s[60:63], s98 offen offset:3072 sc1
    v_mfma_f32_32x32x16_bf16 v[0:15], a[192:195], a[0:3], 0
    s_add_u32 s24, s18, 8192
    buffer_load_dwordx4 a[176:179], v206, s[60:63], s24 offen offset:0 sc1
    v_mfma_f32_32x32x16_bf16 v[16:31], a[192:195], a[4:7], 0
    v_mfma_f32_32x32x16_bf16 v[0:15], a[196:199], a[8:11], v[0:15]
    buffer_load_dwordx4 a[180:183], v206, s[60:63], s24 offen offset:1024 sc1
    v_lshl_add_u32 v194, v242, 3, s32
    v_mfma_f32_32x32x16_bf16 v[16:31], a[196:199], a[12:15], v[16:31]
    v_lshrrev_b32 v196, 4, v242
    s_and_b32 s92, s15, 1
    s_lshl3_add_u32 s92, s92, s88
    s_lshl_b32 s92, s92, 5
    v_lshl_add_u32 v195, v196, 2, s92
    ds_read_b64 v[144:145], v194 offset:0
    v_mfma_f32_32x32x16_bf16 v[32:47], a[200:203], a[0:3], 0
    s_add_u32 s24, s18, 188416
    buffer_load_dwordx4 a[184:187], v206, s[60:63], s24 offen offset:0 sc1
    v_mfma_f32_32x32x16_bf16 v[48:63], a[200:203], a[4:7], 0
    ds_read_b32 v156, v195 offset:32768
    ds_read_b32 v152, v195 offset:33280
    ds_read_b64 v[146:147], v194 offset:512
    ds_read_b32 v157, v195 offset:32784
    ds_read_b32 v153, v195 offset:33296
    v_mfma_f32_32x32x16_bf16 v[32:47], a[204:207], a[8:11], v[32:47]
    buffer_load_dwordx4 a[188:191], v206, s[60:63], s24 offen offset:1024 sc1
    ds_read_b64 v[148:149], v194 offset:1024
    ds_read_b32 v158, v195 offset:32896
    ds_read_b32 v154, v195 offset:33408
    v_mfma_f32_32x32x16_bf16 v[48:63], a[204:207], a[12:15], v[48:63]
    ds_read_b64 v[150:151], v194 offset:1536
    ds_read_b32 v159, v195 offset:32912
    ds_read_b32 v155, v195 offset:33424
    v_and_b32 v192, 15, v242
    v_lshl_add_u32 v194, v192, 3, s32
    v_mfma_f32_32x32x16_bf16 v[64:79], a[208:211], a[0:3], 0
    s_add_u32 s24, s6, 8192
    buffer_load_dwordx4 a[192:195], v206, s[60:63], s24 offen offset:0 sc1
    v_mfma_f32_32x32x16_bf16 v[80:95], a[208:211], a[4:7], 0
    ds_read_b64 v[198:199], v194 offset:2048
    ds_read_b64 v[200:201], v194 offset:2176
    v_and_b32 v193, 3, v242
    v_lshlrev_b32 v193, 5, v193
    v_bfe_u32 v195, v242, 2, 1
    v_lshl_or_b32 v193, v195, 4, v193
    v_mfma_f32_32x32x16_bf16 v[64:79], a[212:215], a[8:11], v[64:79]
    buffer_load_dwordx4 a[196:199], v206, s[60:63], s24 offen offset:1024 sc1
    v_lshl_or_b32 v193, v196, 8, v193
    v_bfe_u32 v195, v242, 3, 1
    v_mfma_f32_32x32x16_bf16 v[80:95], a[212:215], a[12:15], v[80:95]
    v_mul_u32_u24 v195, 4224, v195
    s_and_b32 s92, s88, 1
    s_lshr_b32 s91, s88, 1
    s_lshl4_add_u32 s92, s92, s91
    s_lshl_b32 s92, s92, 7
    v_mfma_f32_32x32x16_bf16 v[96:111], a[216:219], a[0:3], 0
    s_add_u32 s24, s6, 188416
    buffer_load_dwordx4 a[200:203], v206, s[60:63], s24 offen offset:0 sc1
    s_add_u32 s92, s92, 40960
    v_mfma_f32_32x32x16_bf16 v[112:127], a[216:219], a[4:7], 0
    v_add3_u32 v193, v193, v195, s92
    v_lshlrev_b32 v192, 4, v192
    v_lshl_or_b32 v192, v196, 11, v192
    s_lshl_b32 s33, s33, 1
    s_mul_i32 s92, s88, 8448
    v_mfma_f32_32x32x16_bf16 v[96:111], a[220:223], a[8:11], v[96:111]
    buffer_load_dwordx4 a[204:207], v206, s[60:63], s24 offen offset:1024 sc1
    v_mfma_f32_32x32x16_bf16 v[112:127], a[220:223], a[12:15], v[112:127]
    v_mfma_f32_32x32x16_bf16 v[0:15], a[224:227], a[16:19], v[0:15]
    s_add_u32 s24, s18, 12288
    buffer_load_dwordx4 a[208:211], v206, s[60:63], s24 offen offset:0 sc1
    v_mfma_f32_32x32x16_bf16 v[16:31], a[224:227], a[20:23], v[16:31]
    s_waitcnt lgkmcnt(0)
    v_lshlrev_b32 v208, 16, v198
    v_and_b32 v209, 0xffff0000, v198
    v_mfma_f32_32x32x16_bf16 v[0:15], a[228:231], a[24:27], v[0:15]
    buffer_load_dwordx4 a[212:215], v206, s[60:63], s24 offen offset:1024 sc1
    v_lshlrev_b32 v212, 16, v200
    v_mfma_f32_32x32x16_bf16 v[16:31], a[228:231], a[28:31], v[16:31]
    v_and_b32 v213, 0xffff0000, v200
    v_lshlrev_b32 v210, 16, v199
    v_and_b32 v211, 0xffff0000, v199
    v_mfma_f32_32x32x16_bf16 v[32:47], a[232:235], a[16:19], v[32:47]
    s_add_u32 s24, s18, 192512
    buffer_load_dwordx4 a[216:219], v206, s[60:63], s24 offen offset:0 sc1
    v_mfma_f32_32x32x16_bf16 v[48:63], a[232:235], a[20:23], v[48:63]
    v_lshlrev_b32 v214, 16, v201
    v_and_b32 v215, 0xffff0000, v201
    v_lshlrev_b32 v160, 16, v144
    v_mfma_f32_32x32x16_bf16 v[32:47], a[236:239], a[24:27], v[32:47]
    buffer_load_dwordx4 a[220:223], v206, s[60:63], s24 offen offset:1024 sc1
    v_sub_f32 v196, v160, v152
    v_mfma_f32_32x32x16_bf16 v[48:63], a[236:239], a[28:31], v[48:63]
    v_mul_f32 v196, v196, v156
    v_add_f32 v160, v160, v212
    v_fmac_f32 v160, v196, v208
    v_and_b32 v161, 0xffff0000, v144
    s_waitcnt vmcnt(19)
    v_mfma_f32_32x32x16_bf16 v[64:79], a[240:243], a[16:19], v[64:79]
    s_add_u32 s24, s6, 12288
    buffer_load_dwordx4 a[224:227], v206, s[60:63], s24 offen offset:0 sc1
    v_mfma_f32_32x32x16_bf16 v[80:95], a[240:243], a[20:23], v[80:95]
    s_waitcnt vmcnt(13)
    buffer_store_dword v240, v239, s[60:63], s29 offen offset:64 sc1
    v_mfma_f32_32x32x16_bf16 v[64:79], a[244:247], a[24:27], v[64:79]
    buffer_load_dwordx4 a[228:231], v206, s[60:63], s24 offen offset:1024 sc1
    v_mfma_f32_32x32x16_bf16 v[80:95], a[244:247], a[28:31], v[80:95]
    v_sub_f32 v196, v161, v152
    v_mul_f32 v196, v196, v156
    v_add_f32 v161, v161, v213
    v_mfma_f32_32x32x16_bf16 v[96:111], a[248:251], a[16:19], v[96:111]
    s_add_u32 s24, s6, 192512
    buffer_load_dwordx4 a[232:235], v206, s[60:63], s24 offen offset:0 sc1
    v_mfma_f32_32x32x16_bf16 v[112:127], a[248:251], a[20:23], v[112:127]
    s_load_dwordx16 s[44:59], s[8:9], 128 glc
    v_fmac_f32 v161, v196, v209
    v_lshlrev_b32 v162, 16, v145
    v_mfma_f32_32x32x16_bf16 v[96:111], a[252:255], a[24:27], v[96:111]
    buffer_load_dwordx4 a[236:239], v206, s[60:63], s24 offen offset:1024 sc1
    v_sub_f32 v196, v162, v152
    v_mfma_f32_32x32x16_bf16 v[112:127], a[252:255], a[28:31], v[112:127]
    v_mul_f32 v196, v196, v156
    v_add_f32 v162, v162, v214
    v_fmac_f32 v162, v196, v210
    v_and_b32 v163, 0xffff0000, v145
    s_waitcnt vmcnt(15)
    v_mfma_f32_32x32x16_bf16 v[0:15], a[176:179], a[32:35], v[0:15]
    v_sub_f32 v196, v163, v152
    v_mul_f32 v196, v196, v156
    v_add_f32 v163, v163, v215
    v_mfma_f32_32x32x16_bf16 v[16:31], a[176:179], a[36:39], v[16:31]
    v_fmac_f32 v163, v196, v211
    v_lshlrev_b32 v164, 16, v146
    v_sub_f32 v196, v164, v153
    v_mul_f32 v196, v196, v157
    v_mfma_f32_32x32x16_bf16 v[0:15], a[180:183], a[40:43], v[0:15]
    v_add_f32 v164, v164, v212
    v_fmac_f32 v164, v196, v208
    v_and_b32 v165, 0xffff0000, v146
    v_mfma_f32_32x32x16_bf16 v[16:31], a[180:183], a[44:47], v[16:31]
    v_sub_f32 v196, v165, v153
    v_mul_f32 v196, v196, v157
    v_add_f32 v165, v165, v213
    v_fmac_f32 v165, v196, v209
    s_waitcnt vmcnt(13)
    v_mfma_f32_32x32x16_bf16 v[32:47], a[184:187], a[32:35], v[32:47]
    v_lshlrev_b32 v166, 16, v147
    v_sub_f32 v196, v166, v153
    v_mul_f32 v196, v196, v157
    v_mfma_f32_32x32x16_bf16 v[48:63], a[184:187], a[36:39], v[48:63]
    v_add_f32 v166, v166, v214
    v_fmac_f32 v166, v196, v210
    v_and_b32 v167, 0xffff0000, v147
    v_sub_f32 v196, v167, v153
    v_mfma_f32_32x32x16_bf16 v[32:47], a[188:191], a[40:43], v[32:47]
    v_mul_f32 v196, v196, v157
    v_add_f32 v167, v167, v215
    v_fmac_f32 v167, v196, v211
    v_lshlrev_b32 v168, 16, v148
    v_mfma_f32_32x32x16_bf16 v[48:63], a[188:191], a[44:47], v[48:63]
    v_sub_f32 v196, v168, v154
    v_mul_f32 v196, v196, v158
    v_add_f32 v168, v168, v212
    v_fmac_f32 v168, v196, v208
    s_waitcnt vmcnt(11)
    v_mfma_f32_32x32x16_bf16 v[64:79], a[192:195], a[32:35], v[64:79]
    s_mov_b32 s96, 0
L_hf2:
    s_waitcnt lgkmcnt(0)
    s_and_b64 s[44:45], s[44:45], s[46:47]
    s_and_b64 s[44:45], s[44:45], s[48:49]
    s_and_b64 s[44:45], s[44:45], s[50:51]
    s_and_b64 s[44:45], s[44:45], s[52:53]
    s_and_b64 s[44:45], s[44:45], s[54:55]
    s_and_b64 s[44:45], s[44:45], s[56:57]
    s_and_b64 s[44:45], s[44:45], s[58:59]
    s_and_b32 s44, s44, s45
    s_cbranch_scc1 L_hf2_done
    s_add_u32 s96, s96, 1
    s_cmp_ge_u32 s96, 100000
    s_cbranch_scc1 L_hf2_done
    s_load_dwordx16 s[44:59], s[8:9], 128 glc
    s_branch L_hf2
L_hf2_done:
    s_add_u32 s24, s18, 16384
    buffer_load_dwordx4 a[240:243], v206, s[60:63], s24 offen offset:0 sc1
    v_mfma_f32_32x32x16_bf16 v[80:95], a[192:195], a[36:39], v[80:95]
    v_and_b32 v169, 0xffff0000, v148
    v_mfma_f32_32x32x16_bf16 v[64:79], a[196:199], a[40:43], v[64:79]
    buffer_load_dwordx4 a[244:247], v206, s[60:63], s24 offen offset:1024 sc1
    v_sub_f32 v196, v169, v154
    v_mfma_f32_32x32x16_bf16 v[80:95], a[196:199], a[44:47], v[80:95]
    v_mul_f32 v196, v196, v158
    v_add_f32 v169, v169, v213
    v_fmac_f32 v169, v196, v209
    v_lshlrev_b32 v170, 16, v149
    s_waitcnt vmcnt(11)
    v_mfma_f32_32x32x16_bf16 v[96:111], a[200:203], a[32:35], v[96:111]
    s_add_u32 s24, s18, 196608
    buffer_load_dwordx4 a[248:251], v206, s[60:63], s24 offen offset:0 sc1
    v_mfma_f32_32x32x16_bf16 v[112:127], a[200:203], a[36:39], v[112:127]
    v_sub_f32 v196, v170, v154
    v_mul_f32 v196, v196, v158
    v_add_f32 v170, v170, v214
    v_mfma_f32_32x32x16_bf16 v[96:111], a[204:207], a[40:43], v[96:111]
    buffer_load_dwordx4 a[252:255], v206, s[60:63], s24 offen offset:1024 sc1
    v_fmac_f32 v170, v196, v210
    v_mfma_f32_32x32x16_bf16 v[112:127], a[204:207], a[44:47], v[112:127]
    v_and_b32 v171, 0xffff0000, v149
    v_sub_f32 v196, v171, v154
    v_mul_f32 v196, v196, v158
    v_add_f32 v171, v171, v215
    s_waitcnt vmcnt(11)
    v_mfma_f32_32x32x16_bf16 v[0:15], a[208:211], a[48:51], v[0:15]
    s_add_u32 s24, s18, 20480
    buffer_load_dwordx4 a[176:179], v206, s[60:63], s24 offen offset:0 sc1
    v_mfma_f32_32x32x16_bf16 v[16:31], a[208:211], a[52:55], v[16:31]
    v_fmac_f32 v171, v196, v211
    v_lshlrev_b32 v172, 16, v150
    v_mfma_f32_32x32x16_bf16 v[0:15], a[212:215], a[56:59], v[0:15]
    buffer_load_dwordx4 a[180:183], v206, s[60:63], s24 offen offset:1024 sc1
    v_sub_f32 v196, v172, v155
    v_mfma_f32_32x32x16_bf16 v[16:31], a[212:215], a[60:63], v[16:31]
    v_mul_f32 v196, v196, v159
    v_add_f32 v172, v172, v212
    v_fmac_f32 v172, v196, v208
    v_and_b32 v173, 0xffff0000, v150
    s_waitcnt vmcnt(11)
    v_mfma_f32_32x32x16_bf16 v[32:47], a[216:219], a[48:51], v[32:47]
    s_add_u32 s24, s18, 200704
    buffer_load_dwordx4 a[184:187], v206, s[60:63], s24 offen offset:0 sc1
    v_mfma_f32_32x32x16_bf16 v[48:63], a[216:219], a[52:55], v[48:63]
    s_load_dwordx16 s[44:59], s[8:9], 64 glc
    v_sub_f32 v196, v173, v155
    v_mul_f32 v196, v196, v159
    v_mfma_f32_32x32x16_bf16 v[32:47], a[220:223], a[56:59], v[32:47]
    buffer_load_dwordx4 a[188:191], v206, s[60:63], s24 offen offset:1024 sc1
    v_add_f32 v173, v173, v213
    v_mfma_f32_32x32x16_bf16 v[48:63], a[220:223], a[60:63], v[48:63]
    v_fmac_f32 v173, v196, v209
    v_lshlrev_b32 v174, 16, v151
    v_sub_f32 v196, v174, v155
    v_mul_f32 v196, v196, v159
    s_waitcnt vmcnt(10)
    v_mfma_f32_32x32x16_bf16 v[64:79], a[224:227], a[48:51], v[64:79]
    s_add_u32 s24, s18, 24576
    buffer_load_dwordx4 a[192:195], v206, s[60:63], s24 offen offset:0 sc1
    v_mfma_f32_32x32x16_bf16 v[80:95], a[224:227], a[52:55], v[80:95]
    v_add_f32 v174, v174, v214
    v_fmac_f32 v174, v196, v210
    v_mfma_f32_32x32x16_bf16 v[64:79], a[228:231], a[56:59], v[64:79]
    buffer_load_dwordx4 a[196:199], v206, s[60:63], s24 offen offset:1024 sc1
    v_and_b32 v175, 0xffff0000, v151
    v_mfma_f32_32x32x16_bf16 v[80:95], a[228:231], a[60:63], v[80:95]
    v_sub_f32 v196, v175, v155
    v_mul_f32 v196, v196, v159
    v_add_f32 v175, v175, v215
    v_fmac_f32 v175, v196, v211
    s_waitcnt vmcnt(10)
    v_mfma_f32_32x32x16_bf16 v[96:111], a[232:235], a[48:51], v[96:111]
    s_add_u32 s24, s18, 204800
    buffer_load_dwordx4 a[200:203], v206, s[60:63], s24 offen offset:0 sc1
    v_mfma_f32_32x32x16_bf16 v[112:127], a[232:235], a[52:55], v[112:127]
    v_mfma_f32_32x32x16_bf16 v[96:111], a[236:239], a[56:59], v[96:111]
    buffer_load_dwordx4 a[204:207], v206, s[60:63], s24 offen offset:1024 sc1
    v_mfma_f32_32x32x16_bf16 v[112:127], a[236:239], a[60:63], v[112:127]
    s_waitcnt vmcnt(10)
    v_mfma_f32_32x32x16_bf16 v[0:15], a[240:243], a[64:67], v[0:15]
    s_mov_b32 s96, 0
L_hf1:
    s_waitcnt lgkmcnt(0)
    s_and_b64 s[44:45], s[44:45], s[46:47]
    s_and_b64 s[44:45], s[44:45], s[48:49]
    s_and_b64 s[44:45], s[44:45], s[50:51]
    s_and_b64 s[44:45], s[44:45], s[52:53]
    s_and_b64 s[44:45], s[44:45], s[54:55]
    s_and_b64 s[44:45], s[44:45], s[56:57]
    s_and_b64 s[44:45], s[44:45], s[58:59]
    s_and_b32 s44, s44, s45
    s_cbranch_scc1 L_hf1_done
    s_add_u32 s96, s96, 1
    s_cmp_ge_u32 s96, 100000
    s_cbranch_scc1 L_hf1_done
    s_load_dwordx16 s[44:59], s[8:9], 64 glc
    s_branch L_hf1
L_hf1_done:
    s_add_u32 s24, s18, 28672
    buffer_load_dwordx4 a[208:211], v206, s[60:63], s24 offen offset:0 sc1
    v_mfma_f32_32x32x16_bf16 v[16:31], a[240:243], a[68:71], v[16:31]
    s_load_dword s44, s[10:11], 0 glc
    v_mfma_f32_32x32x16_bf16 v[0:15], a[244:247], a[72:75], v[0:15]
    buffer_load_dwordx4 a[212:215], v206, s[60:63], s24 offen offset:1024 sc1
    v_mfma_f32_32x32x16_bf16 v[16:31], a[244:247], a[76:79], v[16:31]
    s_waitcnt vmcnt(10)
    v_mfma_f32_32x32x16_bf16 v[32:47], a[248:251], a[64:67], v[32:47]
    s_add_u32 s24, s18, 32768
    buffer_load_dwordx4 a[216:219], v206, s[60:63], s24 offen offset:0 sc1
    v_mfma_f32_32x32x16_bf16 v[48:63], a[248:251], a[68:71], v[48:63]
    v_mfma_f32_32x32x16_bf16 v[32:47], a[252:255], a[72:75], v[32:47]
    buffer_load_dwordx4 a[220:223], v206, s[60:63], s24 offen offset:1024 sc1
    v_mfma_f32_32x32x16_bf16 v[48:63], a[252:255], a[76:79], v[48:63]
    s_waitcnt vmcnt(10)
    v_mfma_f32_32x32x16_bf16 v[0:15], a[176:179], a[80:83], v[0:15]
    s_add_u32 s24, s18, 36864
    buffer_load_dwordx4 a[224:227], v206, s[60:63], s24 offen offset:0 sc1
    v_mfma_f32_32x32x16_bf16 v[16:31], a[176:179], a[84:87], v[16:31]
    v_mfma_f32_32x32x16_bf16 v[0:15], a[180:183], a[88:91], v[0:15]
    buffer_load_dwordx4 a[228:231], v206, s[60:63], s24 offen offset:1024 sc1
    v_mfma_f32_32x32x16_bf16 v[16:31], a[180:183], a[92:95], v[16:31]
    s_waitcnt vmcnt(10)
    v_mfma_f32_32x32x16_bf16 v[32:47], a[184:187], a[80:83], v[32:47]
    s_add_u32 s24, s18, 40960
    buffer_load_dwordx4 a[232:235], v206, s[60:63], s24 offen offset:0 sc1
    v_mfma_f32_32x32x16_bf16 v[48:63], a[184:187], a[84:87], v[48:63]
    v_mfma_f32_32x32x16_bf16 v[32:47], a[188:191], a[88:91], v[32:47]
    buffer_load_dwordx4 a[236:239], v206, s[60:63], s24 offen offset:1024 sc1
    v_mfma_f32_32x32x16_bf16 v[48:63], a[188:191], a[92:95], v[48:63]
    s_waitcnt vmcnt(10)
    v_mfma_f32_32x32x16_bf16 v[0:15], a[192:195], a[96:99], v[0:15]
    s_add_u32 s24, s18, 208896
    buffer_load_dwordx4 a[240:243], v206, s[60:63], s24 offen offset:0 sc1
    v_mfma_f32_32x32x16_bf16 v[16:31], a[192:195], a[100:103], v[16:31]
    v_mfma_f32_32x32x16_bf16 v[0:15], a[196:199], a[104:107], v[0:15]
    buffer_load_dwordx4 a[244:247], v206, s[60:63], s24 offen offset:1024 sc1
    v_mfma_f32_32x32x16_bf16 v[16:31], a[196:199], a[108:111], v[16:31]
    s_waitcnt vmcnt(10)
    v_mfma_f32_32x32x16_bf16 v[32:47], a[200:203], a[96:99], v[32:47]
    s_add_u32 s24, s18, 212992
    buffer_load_dwordx4 a[248:251], v206, s[60:63], s24 offen offset:0 sc1
    v_mfma_f32_32x32x16_bf16 v[48:63], a[200:203], a[100:103], v[48:63]
    v_mfma_f32_32x32x16_bf16 v[32:47], a[204:207], a[104:107], v[32:47]
    buffer_load_dwordx4 a[252:255], v206, s[60:63], s24 offen offset:1024 sc1
    v_mfma_f32_32x32x16_bf16 v[48:63], a[204:207], a[108:111], v[48:63]
    s_waitcnt vmcnt(10)
    v_mfma_f32_32x32x16_bf16 v[0:15], a[208:211], a[112:115], v[0:15]
    s_add_u32 s24, s18, 217088
    buffer_load_dwordx4 a[176:179], v206, s[60:63], s24 offen offset:0 sc1
    v_mfma_f32_32x32x16_bf16 v[16:31], a[208:211], a[116:119], v[16:31]
    v_mfma_f32_32x32x16_bf16 v[0:15], a[212:215], a[120:123], v[0:15]
    buffer_load_dwordx4 a[180:183], v206, s[60:63], s24 offen offset:1024 sc1
    v_mfma_f32_32x32x16_bf16 v[16:31], a[212:215], a[124:127], v[16:31]
    s_waitcnt vmcnt(10)
    v_mfma_f32_32x32x16_bf16 v[0:15], a[216:219], a[128:131], v[0:15]
    s_add_u32 s24, s18, 221184
    buffer_load_dwordx4 a[184:187], v206, s[60:63], s24 offen offset:0 sc1
    v_mfma_f32_32x32x16_bf16 v[16:31], a[216:219], a[132:135], v[16:31]
    s_mov_b32 s96, 0
L_xr:
    s_waitcnt lgkmcnt(0)
    s_and_b32 s44, s44, s44
    s_cbranch_scc1 L_xr_done
    s_add_u32 s96, s96, 1
    s_cmp_ge_u32 s96, 100000
    s_cbranch_scc1 L_xr_done
    s_load_dword s44, s[10:11], 0 glc
    s_branch L_xr
L_xr_done:
    v_mfma_f32_32x32x16_bf16 v[0:15], a[220:223], a[136:139], v[0:15]
    buffer_load_dwordx4 a[188:191], v206, s[60:63], s24 offen offset:1024 sc1
    v_mfma_f32_32x32x16_bf16 v[16:31], a[220:223], a[140:143], v[16:31]
    s_waitcnt vmcnt(10)
    v_mfma_f32_32x32x16_bf16 v[0:15], a[224:227], a[144:147], v[0:15]
    s_add_u32 s24, s6, 16384
    buffer_load_dwordx4 a[192:195], v206, s[60:63], s24 offen offset:0 sc1
    v_mfma_f32_32x32x16_bf16 v[16:31], a[224:227], a[148:151], v[16:31]
    v_mfma_f32_32x32x16_bf16 v[0:15], a[228:231], a[152:155], v[0:15]
    buffer_load_dwordx4 a[196:199], v206, s[60:63], s24 offen offset:1024 sc1
    v_mfma_f32_32x32x16_bf16 v[16:31], a[228:231], a[156:159], v[16:31]
    s_waitcnt vmcnt(10)
    v_mfma_f32_32x32x16_bf16 v[0:15], a[232:235], a[160:163], v[0:15]
    s_add_u32 s24, s6, 20480
    buffer_load_dwordx4 a[200:203], v206, s[60:63], s24 offen offset:0 sc1
    v_mfma_f32_32x32x16_bf16 v[16:31], a[232:235], a[164:167], v[16:31]
    v_mfma_f32_32x32x16_bf16 v[0:15], a[236:239], a[168:171], v[0:15]
    buffer_load_dwordx4 a[204:207], v206, s[60:63], s24 offen offset:1024 sc1
    v_mfma_f32_32x32x16_bf16 v[16:31], a[236:239], a[172:175], v[16:31]
    s_waitcnt vmcnt(10)
    v_mfma_f32_32x32x16_bf16 v[32:47], a[240:243], a[112:115], v[32:47]
    s_add_u32 s24, s6, 24576
    buffer_load_dwordx4 a[208:211], v206, s[60:63], s24 offen offset:0 sc1
    v_mfma_f32_32x32x16_bf16 v[48:63], a[240:243], a[116:119], v[48:63]
    v_mfma_f32_32x32x16_bf16 v[32:47], a[244:247], a[120:123], v[32:47]
    buffer_load_dwordx4 a[212:215], v206, s[60:63], s24 offen offset:1024 sc1
    s_add_u32 m0, s92, 0
    s_nop 1
    ds_write_addtid_b32 v0 offset:40960
    ds_write_addtid_b32 v1 offset:41216
    ds_write_addtid_b32 v2 offset:41472
    v_mfma_f32_32x32x16_bf16 v[48:63], a[244:247], a[124:127], v[48:63]
    ds_write_addtid_b32 v3 offset:41728
    ds_write_addtid_b32 v4 offset:41984
    ds_write_addtid_b32 v5 offset:42240
    ds_write_addtid_b32 v6 offset:42496
    ds_write_addtid_b32 v7 offset:42752
    s_waitcnt vmcnt(10)
    v_mfma_f32_32x32x16_bf16 v[32:47], a[248:251], a[128:131], v[32:47]
    s_add_u32 s24, s6, 28672
    buffer_load_dwordx4 a[216:219], v206, s[60:63], s24 offen offset:0 sc1
    ds_write_addtid_b32 v8 offset:43008
    ds_write_addtid_b32 v9 offset:43264
    ds_write_addtid_b32 v10 offset:43520
    v_mfma_f32_32x32x16_bf16 v[48:63], a[248:251], a[132:135], v[48:63]
    ds_write_addtid_b32 v11 offset:43776
    ds_write_addtid_b32 v12 offset:44032
    ds_write_addtid_b32 v13 offset:44288
    ds_write_addtid_b32 v14 offset:44544
    ds_write_addtid_b32 v15 offset:44800
    v_mfma_f32_32x32x16_bf16 v[32:47], a[252:255], a[136:139], v[32:47]
    buffer_load_dwordx4 a[220:223], v206, s[60:63], s24 offen offset:1024 sc1
    ds_write_addtid_b32 v16 offset:45184
    ds_write_addtid_b32 v17 offset:45440
    ds_write_addtid_b32 v18 offset:45696
    v_mfma_f32_32x32x16_bf16 v[48:63], a[252:255], a[140:143], v[48:63]
    ds_write_addtid_b32 v19 offset:45952
    ds_write_addtid_b32 v20 offset:46208
    ds_write_addtid_b32 v21 offset:46464
    ds_write_addtid_b32 v22 offset:46720
    ds_write_addtid_b32 v23 offset:46976
    s_waitcnt vmcnt(10)
    v_mfma_f32_32x32x16_bf16 v[32:47], a[176:179], a[144:147], v[32:47]
    s_add_u32 s24, s6, 32768
    buffer_load_dwordx4 a[224:227], v206, s[60:63], s24 offen offset:0 sc1
    ds_write_addtid_b32 v24 offset:47232
    ds_write_addtid_b32 v25 offset:47488
    ds_write_addtid_b32 v26 offset:47744
    v_mfma_f32_32x32x16_bf16 v[48:63], a[176:179], a[148:151], v[48:63]
    ds_write_addtid_b32 v27 offset:48000
    ds_write_addtid_b32 v28 offset:48256
    ds_write_addtid_b32 v29 offset:48512
    ds_write_addtid_b32 v30 offset:48768
    ds_write_addtid_b32 v31 offset:49024
    v_mfma_f32_32x32x16_bf16 v[32:47], a[180:183], a[152:155], v[32:47]
    buffer_load_dwordx4 a[228:231], v206, s[60:63], s24 offen offset:1024 sc1
    v_mfma_f32_32x32x16_bf16 v[48:63], a[180:183], a[156:159], v[48:63]
    s_waitcnt vmcnt(10)
    v_mfma_f32_32x32x16_bf16 v[32:47], a[184:187], a[160:163], v[32:47]
    s_add_u32 s24, s6, 36864
    buffer_load_dwordx4 a[232:235], v206, s[60:63], s24 offen offset:0 sc1
    s_waitcnt lgkmcnt(0)
    s_barrier
    ds_read_b128 v[0:3], v193 offset:0
    v_mfma_f32_32x32x16_bf16 v[48:63], a[184:187], a[164:167], v[48:63]
    ds_read_b128 v[4:7], v193 offset:8448
    ds_read_b128 v[8:11], v193 offset:16896
    ds_read_b128 v[12:15], v193 offset:25344
    ds_read_b128 v[16:19], v193 offset:1024
    ds_read_b128 v[20:23], v193 offset:9472
    ds_read_b128 v[24:27], v193 offset:17920
    ds_read_b128 v[28:31], v193 offset:26368
    v_mfma_f32_32x32x16_bf16 v[32:47], a[188:191], a[168:171], v[32:47]
    buffer_load_dwordx4 a[236:239], v206, s[60:63], s24 offen offset:1024 sc1
    v_mfma_f32_32x32x16_bf16 v[48:63], a[188:191], a[172:175], v[48:63]
    s_waitcnt vmcnt(10)
    v_mfma_f32_32x32x16_bf16 v[64:79], a[192:195], a[64:67], v[64:79]
    s_add_u32 s24, s6, 40960
    buffer_load_dwordx4 a[240:243], v206, s[60:63], s24 offen offset:0 sc1
    s_waitcnt lgkmcnt(4)
    v_add_f32 v0, v0, v4
    v_add_f32 v1, v1, v5
    v_add_f32 v2, v2, v6
    v_add_f32 v3, v3, v7
    v_add_f32 v8, v8, v12
    v_add_f32 v9, v9, v13
    v_add_f32 v10, v10, v14
    v_add_f32 v11, v11, v15
    v_add_f32 v0, v0, v8
    v_mfma_f32_32x32x16_bf16 v[80:95], a[192:195], a[68:71], v[80:95]
    v_add_f32 v1, v1, v9
    v_add_f32 v2, v2, v10
    v_add_f32 v3, v3, v11
    v_cvt_pk_bf16_f32 v4, v0, v1
    v_cvt_pk_bf16_f32 v5, v2, v3
    s_waitcnt lgkmcnt(0)
    v_add_f32 v16, v16, v20
    v_add_f32 v17, v17, v21
    v_add_f32 v18, v18, v22
    v_add_f32 v19, v19, v23
    v_add_f32 v24, v24, v28
    v_add_f32 v25, v25, v29
    v_add_f32 v26, v26, v30
    v_add_f32 v27, v27, v31
    v_add_f32 v16, v16, v24
    v_mfma_f32_32x32x16_bf16 v[64:79], a[196:199], a[72:75], v[64:79]
    buffer_load_dwordx4 a[244:247], v206, s[60:63], s24 offen offset:1024 sc1
    v_add_f32 v17, v17, v25
    v_add_f32 v18, v18, v26
    v_add_f32 v19, v19, v27
    v_cvt_pk_bf16_f32 v6, v16, v17
    v_cvt_pk_bf16_f32 v7, v18, v19
    buffer_store_dwordx4 v[4:7], v206, s[60:63], s13 offen offset:0 sc1
    v_mfma_f32_32x32x16_bf16 v[80:95], a[196:199], a[76:79], v[80:95]
    s_add_u32 m0, s92, 33792
    s_nop 0
    ds_write_addtid_b32 v32 offset:40960
    ds_write_addtid_b32 v33 offset:41216
    ds_write_addtid_b32 v34 offset:41472
    ds_write_addtid_b32 v35 offset:41728
    ds_write_addtid_b32 v36 offset:41984
    ds_write_addtid_b32 v37 offset:42240
    ds_write_addtid_b32 v38 offset:42496
    s_waitcnt vmcnt(11)
    v_mfma_f32_32x32x16_bf16 v[64:79], a[200:203], a[80:83], v[64:79]
    s_add_u32 s24, s6, 196608
    buffer_load_dwordx4 a[248:251], v206, s[60:63], s24 offen offset:0 sc1
    ds_write_addtid_b32 v39 offset:42752
    ds_write_addtid_b32 v40 offset:43008
    ds_write_addtid_b32 v41 offset:43264
    ds_write_addtid_b32 v42 offset:43520
    ds_write_addtid_b32 v43 offset:43776
    v_mfma_f32_32x32x16_bf16 v[80:95], a[200:203], a[84:87], v[80:95]
    ds_write_addtid_b32 v44 offset:44032
    ds_write_addtid_b32 v45 offset:44288
    ds_write_addtid_b32 v46 offset:44544
    ds_write_addtid_b32 v47 offset:44800
    ds_write_addtid_b32 v48 offset:45184
    ds_write_addtid_b32 v49 offset:45440
    ds_write_addtid_b32 v50 offset:45696
    v_mfma_f32_32x32x16_bf16 v[64:79], a[204:207], a[88:91], v[64:79]
    buffer_load_dwordx4 a[252:255], v206, s[60:63], s24 offen offset:1024 sc1
    ds_write_addtid_b32 v51 offset:45952
    ds_write_addtid_b32 v52 offset:46208
    ds_write_addtid_b32 v53 offset:46464
    ds_write_addtid_b32 v54 offset:46720
    ds_write_addtid_b32 v55 offset:46976
    ds_write_addtid_b32 v56 offset:47232
    v_mfma_f32_32x32x16_bf16 v[80:95], a[204:207], a[92:95], v[80:95]
    ds_write_addtid_b32 v57 offset:47488
    ds_write_addtid_b32 v58 offset:47744
    ds_write_addtid_b32 v59 offset:48000
    ds_write_addtid_b32 v60 offset:48256
    ds_write_addtid_b32 v61 offset:48512
    ds_write_addtid_b32 v62 offset:48768
    ds_write_addtid_b32 v63 offset:49024
    s_waitcnt vmcnt(11)
    v_mfma_f32_32x32x16_bf16 v[64:79], a[208:211], a[96:99], v[64:79]
    s_add_u32 s24, s6, 200704
    buffer_load_dwordx4 a[176:179], v206, s[60:63], s24 offen offset:0 sc1
    v_mfma_f32_32x32x16_bf16 v[80:95], a[208:211], a[100:103], v[80:95]
    v_mfma_f32_32x32x16_bf16 v[64:79], a[212:215], a[104:107], v[64:79]
    buffer_load_dwordx4 a[180:183], v206, s[60:63], s24 offen offset:1024 sc1
    s_waitcnt lgkmcnt(0)
    s_barrier
    ds_read_b128 v[32:35], v193 offset:33792
    ds_read_b128 v[36:39], v193 offset:42240
    v_mfma_f32_32x32x16_bf16 v[80:95], a[212:215], a[108:111], v[80:95]
    ds_read_b128 v[40:43], v193 offset:50688
    ds_read_b128 v[44:47], v193 offset:59136
    ds_read_b128 v[48:51], v193 offset:34816
    ds_read_b128 v[52:55], v193 offset:43264
    ds_read_b128 v[56:59], v193 offset:51712
    ds_read_b128 v[60:63], v193 offset:60160
    s_waitcnt vmcnt(11)
    v_mfma_f32_32x32x16_bf16 v[64:79], a[216:219], a[112:115], v[64:79]
    s_add_u32 s24, s6, 204800
    buffer_load_dwordx4 a[184:187], v206, s[60:63], s24 offen offset:0 sc1
    v_mfma_f32_32x32x16_bf16 v[80:95], a[216:219], a[116:119], v[80:95]
    v_mfma_f32_32x32x16_bf16 v[64:79], a[220:223], a[120:123], v[64:79]
    buffer_load_dwordx4 a[188:191], v206, s[60:63], s24 offen offset:1024 sc1
    s_waitcnt lgkmcnt(4)
    v_add_f32 v32, v32, v36
    v_add_f32 v33, v33, v37
    v_add_f32 v34, v34, v38
    v_add_f32 v35, v35, v39
    v_add_f32 v40, v40, v44
    v_add_f32 v41, v41, v45
    v_mfma_f32_32x32x16_bf16 v[80:95], a[220:223], a[124:127], v[80:95]
    v_add_f32 v42, v42, v46
    v_add_f32 v43, v43, v47
    v_add_f32 v32, v32, v40
    v_add_f32 v33, v33, v41
    v_add_f32 v34, v34, v42
    v_add_f32 v35, v35, v43
    v_cvt_pk_bf16_f32 v36, v32, v33
    v_cvt_pk_bf16_f32 v37, v34, v35
    s_waitcnt lgkmcnt(0)
    s_waitcnt vmcnt(11)
    v_mfma_f32_32x32x16_bf16 v[64:79], a[224:227], a[128:131], v[64:79]
    s_add_u32 s24, s6, 208896
    buffer_load_dwordx4 a[192:195], v206, s[60:63], s24 offen offset:0 sc1
    v_add_f32 v48, v48, v52
    v_add_f32 v49, v49, v53
    v_add_f32 v50, v50, v54
    v_add_f32 v51, v51, v55
    v_add_f32 v56, v56, v60
    v_mfma_f32_32x32x16_bf16 v[80:95], a[224:227], a[132:135], v[80:95]
    v_add_f32 v57, v57, v61
    v_add_f32 v58, v58, v62
    v_add_f32 v59, v59, v63
    v_add_f32 v48, v48, v56
    v_add_f32 v49, v49, v57
    v_add_f32 v50, v50, v58
    v_add_f32 v51, v51, v59
    v_cvt_pk_bf16_f32 v38, v48, v49
    v_cvt_pk_bf16_f32 v39, v50, v51
    v_mfma_f32_32x32x16_bf16 v[64:79], a[228:231], a[136:139], v[64:79]
    buffer_load_dwordx4 a[196:199], v206, s[60:63], s24 offen offset:1024 sc1
    buffer_store_dwordx4 v[36:39], v206, s[60:63], s13 offen offset:1024 sc1
    v_mfma_f32_32x32x16_bf16 v[80:95], a[228:231], a[140:143], v[80:95]
    s_waitcnt vmcnt(12)
    v_mfma_f32_32x32x16_bf16 v[64:79], a[232:235], a[144:147], v[64:79]
    s_add_u32 s24, s6, 212992
    buffer_load_dwordx4 a[200:203], v206, s[60:63], s24 offen offset:0 sc1
    v_mfma_f32_32x32x16_bf16 v[80:95], a[232:235], a[148:151], v[80:95]
    v_mfma_f32_32x32x16_bf16 v[64:79], a[236:239], a[152:155], v[64:79]
    buffer_load_dwordx4 a[204:207], v206, s[60:63], s24 offen offset:1024 sc1
    v_mfma_f32_32x32x16_bf16 v[80:95], a[236:239], a[156:159], v[80:95]
    s_waitcnt vmcnt(12)
    v_mfma_f32_32x32x16_bf16 v[64:79], a[240:243], a[160:163], v[64:79]
    s_add_u32 s24, s6, 217088
    buffer_load_dwordx4 a[208:211], v206, s[60:63], s24 offen offset:0 sc1
    v_mfma_f32_32x32x16_bf16 v[80:95], a[240:243], a[164:167], v[80:95]
    v_mfma_f32_32x32x16_bf16 v[64:79], a[244:247], a[168:171], v[64:79]
    buffer_load_dwordx4 a[212:215], v206, s[60:63], s24 offen offset:1024 sc1
    buffer_load_dwordx4 v[128:131], v206, s[60:63], s12 offen offset:0 sc1
    v_mfma_f32_32x32x16_bf16 v[80:95], a[244:247], a[172:175], v[80:95]
    s_waitcnt vmcnt(12)
    v_mfma_f32_32x32x16_bf16 v[96:111], a[248:251], a[64:67], v[96:111]
    s_add_u32 s24, s6, 221184
    buffer_load_dwordx4 a[216:219], v206, s[60:63], s24 offen offset:0 sc1
    v_mfma_f32_32x32x16_bf16 v[112:127], a[248:251], a[68:71], v[112:127]
    v_mfma_f32_32x32x16_bf16 v[96:111], a[252:255], a[72:75], v[96:111]
    buffer_load_dwordx4 a[220:223], v206, s[60:63], s24 offen offset:1024 sc1
    s_add_u32 m0, s92, 0
    s_nop 0
    ds_write_addtid_b32 v64 offset:40960
    ds_write_addtid_b32 v65 offset:41216
    ds_write_addtid_b32 v66 offset:41472
    ds_write_addtid_b32 v67 offset:41728
    ds_write_addtid_b32 v68 offset:41984
    v_mfma_f32_32x32x16_bf16 v[112:127], a[252:255], a[76:79], v[112:127]
    ds_write_addtid_b32 v69 offset:42240
    ds_write_addtid_b32 v70 offset:42496
    ds_write_addtid_b32 v71 offset:42752
    ds_write_addtid_b32 v72 offset:43008
    ds_write_addtid_b32 v73 offset:43264
    ds_write_addtid_b32 v74 offset:43520
    ds_write_addtid_b32 v75 offset:43776
    s_waitcnt vmcnt(12)
    v_mfma_f32_32x32x16_bf16 v[96:111], a[176:179], a[80:83], v[96:111]
    ds_write_addtid_b32 v76 offset:44032
    ds_write_addtid_b32 v77 offset:44288
    ds_write_addtid_b32 v78 offset:44544
    ds_write_addtid_b32 v79 offset:44800
    ds_write_addtid_b32 v80 offset:45184
    ds_write_addtid_b32 v81 offset:45440
    v_mfma_f32_32x32x16_bf16 v[112:127], a[176:179], a[84:87], v[112:127]
    ds_write_addtid_b32 v82 offset:45696
    ds_write_addtid_b32 v83 offset:45952
    ds_write_addtid_b32 v84 offset:46208
    ds_write_addtid_b32 v85 offset:46464
    ds_write_addtid_b32 v86 offset:46720
    ds_write_addtid_b32 v87 offset:46976
    ds_write_addtid_b32 v88 offset:47232
    v_mfma_f32_32x32x16_bf16 v[96:111], a[180:183], a[88:91], v[96:111]
    ds_write_addtid_b32 v89 offset:47488
    ds_write_addtid_b32 v90 offset:47744
    ds_write_addtid_b32 v91 offset:48000
    ds_write_addtid_b32 v92 offset:48256
    ds_write_addtid_b32 v93 offset:48512
    ds_write_addtid_b32 v94 offset:48768
    ds_write_addtid_b32 v95 offset:49024
    v_mfma_f32_32x32x16_bf16 v[112:127], a[180:183], a[92:95], v[112:127]
    s_waitcnt vmcnt(10)
    v_mfma_f32_32x32x16_bf16 v[96:111], a[184:187], a[96:99], v[96:111]
    v_mfma_f32_32x32x16_bf16 v[112:127], a[184:187], a[100:103], v[112:127]
    s_waitcnt lgkmcnt(0)
    s_barrier
    ds_read_b128 v[64:67], v193 offset:0
    ds_read_b128 v[68:71], v193 offset:8448
    ds_read_b128 v[72:75], v193 offset:16896
    v_mfma_f32_32x32x16_bf16 v[96:111], a[188:191], a[104:107], v[96:111]
    ds_read_b128 v[76:79], v193 offset:25344
    ds_read_b128 v[80:83], v193 offset:1024
    ds_read_b128 v[84:87], v193 offset:9472
    ds_read_b128 v[88:91], v193 offset:17920
    ds_read_b128 v[92:95], v193 offset:26368
    v_mfma_f32_32x32x16_bf16 v[112:127], a[188:191], a[108:111], v[112:127]
    s_waitcnt vmcnt(8)
    v_mfma_f32_32x32x16_bf16 v[96:111], a[192:195], a[112:115], v[96:111]
    buffer_load_dwordx4 v[132:135], v206, s[60:63], s12 offen offset:1024 sc1
    v_mfma_f32_32x32x16_bf16 v[112:127], a[192:195], a[116:119], v[112:127]
    s_waitcnt lgkmcnt(4)
    v_add_f32 v64, v64, v68
    v_add_f32 v65, v65, v69
    v_add_f32 v66, v66, v70
    v_add_f32 v67, v67, v71
    v_add_f32 v72, v72, v76
    v_add_f32 v73, v73, v77
    v_mfma_f32_32x32x16_bf16 v[96:111], a[196:199], a[120:123], v[96:111]
    v_add_f32 v74, v74, v78
    v_add_f32 v75, v75, v79
    v_add_f32 v160, v160, v64
    v_add_f32 v161, v161, v65
    v_add_f32 v162, v162, v66
    v_add_f32 v163, v163, v67
    v_add_f32 v160, v160, v72
    v_mfma_f32_32x32x16_bf16 v[112:127], a[196:199], a[124:127], v[112:127]
    v_add_f32 v161, v161, v73
    v_add_f32 v162, v162, v74
    v_add_f32 v163, v163, v75
    s_waitcnt lgkmcnt(0)
    v_add_f32 v80, v80, v84
    v_add_f32 v81, v81, v85
    v_add_f32 v82, v82, v86
    s_waitcnt vmcnt(6)
    v_mfma_f32_32x32x16_bf16 v[96:111], a[200:203], a[128:131], v[96:111]
    v_add_f32 v83, v83, v87
    v_add_f32 v88, v88, v92
    v_add_f32 v89, v89, v93
    v_add_f32 v90, v90, v94
    v_add_f32 v91, v91, v95
    v_add_f32 v164, v164, v80
    v_mfma_f32_32x32x16_bf16 v[112:127], a[200:203], a[132:135], v[112:127]
    v_add_f32 v165, v165, v81
    v_add_f32 v166, v166, v82
    v_add_f32 v167, v167, v83
    v_add_f32 v164, v164, v88
    v_add_f32 v165, v165, v89
    v_add_f32 v166, v166, v90
    v_add_f32 v167, v167, v91
    v_mfma_f32_32x32x16_bf16 v[96:111], a[204:207], a[136:139], v[96:111]
    v_mfma_f32_32x32x16_bf16 v[112:127], a[204:207], a[140:143], v[112:127]
    s_waitcnt vmcnt(3)
    s_mov_b32 s96, 0
L_xc0:
    v_max3_u32 v196, v128, v129, v130
    v_max_u32 v196, v196, v131
    v_cmp_eq_u32 vcc, -1, v196
    s_nop 1
    s_cmp_eq_u64 vcc, 0
    s_cbranch_scc1 L_xc0_done
    s_add_u32 s96, s96, 1
    s_cmp_ge_u32 s96, 100000
    s_cbranch_scc1 L_xc0_done
    buffer_load_dwordx4 v[128:131], v206, s[60:63], s12 offen offset:0 sc1
    s_waitcnt vmcnt(0)
    s_branch L_xc0
L_xc0_done:
    v_lshlrev_b32 v136, 16, v128
    v_and_b32 v137, 0xffff0000, v128
    v_lshlrev_b32 v138, 16, v129
    v_and_b32 v139, 0xffff0000, v129
    s_add_u32 s91, s33, 0
    s_waitcnt vmcnt(1)
    v_mfma_f32_32x32x16_bf16 v[96:111], a[208:211], a[144:147], v[96:111]
    v_add_f32 v160, v160, v136
    v_add_f32 v161, v161, v137
    v_add_f32 v162, v162, v138
    v_add_f32 v163, v163, v139
    v_mfma_f32_32x32x16_bf16 v[96:111], a[212:215], a[152:155], v[96:111]
    buffer_store_dwordx4 v[160:163], v192, s[76:79], s91 offen sc1
    v_mfma_f32_32x32x16_bf16 v[96:111], a[216:219], a[160:163], v[96:111]
    v_lshlrev_b32 v136, 16, v130
    v_and_b32 v137, 0xffff0000, v130
    v_lshlrev_b32 v138, 16, v131
    v_and_b32 v139, 0xffff0000, v131
    v_mfma_f32_32x32x16_bf16 v[96:111], a[220:223], a[168:171], v[96:111]
    s_add_u32 s91, s33, 8192
    v_add_f32 v164, v164, v136
    v_add_f32 v165, v165, v137
    v_add_f32 v166, v166, v138
    v_add_f32 v167, v167, v139
    v_mfma_f32_32x32x16_bf16 v[112:127], a[208:211], a[148:151], v[112:127]
    buffer_store_dwordx4 v[164:167], v192, s[76:79], s91 offen sc1
    v_mfma_f32_32x32x16_bf16 v[112:127], a[212:215], a[156:159], v[112:127]
    s_add_u32 m0, s92, 33792
    s_nop 2
    ds_write_addtid_b32 v96 offset:40960
    ds_write_addtid_b32 v97 offset:41216
    ds_write_addtid_b32 v98 offset:41472
    ds_write_addtid_b32 v99 offset:41728
    ds_write_addtid_b32 v100 offset:41984
    v_mfma_f32_32x32x16_bf16 v[112:127], a[216:219], a[164:167], v[112:127]
    ds_write_addtid_b32 v101 offset:42240
    ds_write_addtid_b32 v102 offset:42496
    ds_write_addtid_b32 v103 offset:42752
    ds_write_addtid_b32 v104 offset:43008
    ds_write_addtid_b32 v105 offset:43264
    ds_write_addtid_b32 v106 offset:43520
    v_mfma_f32_32x32x16_bf16 v[112:127], a[220:223], a[172:175], v[112:127]
    ds_write_addtid_b32 v107 offset:43776
    ds_write_addtid_b32 v108 offset:44032
    ds_write_addtid_b32 v109 offset:44288
    ds_write_addtid_b32 v110 offset:44544
    ds_write_addtid_b32 v111 offset:44800
    s_nop 6
    ds_write_addtid_b32 v112 offset:45184
    ds_write_addtid_b32 v113 offset:45440
    ds_write_addtid_b32 v114 offset:45696
    ds_write_addtid_b32 v115 offset:45952
    ds_write_addtid_b32 v116 offset:46208
    ds_write_addtid_b32 v117 offset:46464
    ds_write_addtid_b32 v118 offset:46720
    ds_write_addtid_b32 v119 offset:46976
    ds_write_addtid_b32 v120 offset:47232
    ds_write_addtid_b32 v121 offset:47488
    ds_write_addtid_b32 v122 offset:47744
    ds_write_addtid_b32 v123 offset:48000
    ds_write_addtid_b32 v124 offset:48256
    ds_write_addtid_b32 v125 offset:48512
    ds_write_addtid_b32 v126 offset:48768
    ds_write_addtid_b32 v127 offset:49024
    s_waitcnt vmcnt(2)
    s_mov_b32 s96, 0
L_xc1:
    v_max3_u32 v196, v132, v133, v134
    v_max_u32 v196, v196, v135
    v_cmp_eq_u32 vcc, -1, v196
    s_nop 1
    s_cmp_eq_u64 vcc, 0
    s_cbranch_scc1 L_xc1_done
    s_add_u32 s96, s96, 1
    s_cmp_ge_u32 s96, 100000
    s_cbranch_scc1 L_xc1_done
    buffer_load_dwordx4 v[132:135], v206, s[60:63], s12 offen offset:1024 sc1
    s_waitcnt vmcnt(0)
    s_branch L_xc1
L_xc1_done:
    v_lshlrev_b32 v136, 16, v132
    v_and_b32 v137, 0xffff0000, v132
    v_lshlrev_b32 v138, 16, v133
    v_and_b32 v139, 0xffff0000, v133
    v_pk_add_f32 v[168:169], v[168:169], v[136:137]
    v_pk_add_f32 v[170:171], v[170:171], v[138:139]
    v_lshlrev_b32 v136, 16, v134
    v_and_b32 v137, 0xffff0000, v134
    v_lshlrev_b32 v138, 16, v135
    v_and_b32 v139, 0xffff0000, v135
    v_pk_add_f32 v[172:173], v[172:173], v[136:137]
    v_pk_add_f32 v[174:175], v[174:175], v[138:139]
    s_waitcnt lgkmcnt(0)
    s_barrier
    ds_read_b128 v[96:99], v193 offset:33792
    ds_read_b128 v[100:103], v193 offset:42240
    ds_read_b128 v[104:107], v193 offset:50688
    ds_read_b128 v[108:111], v193 offset:59136
    ds_read_b128 v[112:115], v193 offset:34816
    ds_read_b128 v[116:119], v193 offset:43264
    ds_read_b128 v[120:123], v193 offset:51712
    ds_read_b128 v[124:127], v193 offset:60160
    s_add_u32 s91, s33, 65536
    s_waitcnt lgkmcnt(4)
    v_pk_add_f32 v[96:97], v[96:97], v[100:101]
    v_pk_add_f32 v[98:99], v[98:99], v[102:103]
    v_pk_add_f32 v[104:105], v[104:105], v[108:109]
    v_pk_add_f32 v[106:107], v[106:107], v[110:111]
    v_pk_add_f32 v[168:169], v[168:169], v[96:97]
    v_pk_add_f32 v[170:171], v[170:171], v[98:99]
    v_pk_add_f32 v[168:169], v[168:169], v[104:105]
    v_pk_add_f32 v[170:171], v[170:171], v[106:107]
    buffer_store_dwordx4 v[168:171], v192, s[76:79], s91 offen sc1
    s_add_u32 s91, s33, 73728
    s_waitcnt lgkmcnt(0)
    v_pk_add_f32 v[112:113], v[112:113], v[116:117]
    v_pk_add_f32 v[114:115], v[114:115], v[118:119]
    v_pk_add_f32 v[120:121], v[120:121], v[124:125]
    v_pk_add_f32 v[122:123], v[122:123], v[126:127]
    v_pk_add_f32 v[172:173], v[172:173], v[112:113]
    v_pk_add_f32 v[174:175], v[174:175], v[114:115]
    v_pk_add_f32 v[172:173], v[172:173], v[120:121]
    v_pk_add_f32 v[174:175], v[174:175], v[122:123]
    buffer_store_dwordx4 v[172:175], v192, s[76:79], s91 offen sc1
L_end:
    s_endpgm
.section .rodata,"a"
.p2align 6
.amdhsa_kernel parallel_sum__ssm_conv_s5__mixer_channel_mlp__prompt_kernel
  .amdhsa_next_free_vgpr 512
  .amdhsa_next_free_sgpr 102
  .amdhsa_accum_offset 256
  .amdhsa_group_segment_fixed_size 0
  .amdhsa_float_denorm_mode_32 3
  .amdhsa_kernarg_size 136
  .amdhsa_user_sgpr_count 2
  .amdhsa_user_sgpr_kernarg_segment_ptr 1
  .amdhsa_system_sgpr_workgroup_id_x 1
.end_amdhsa_kernel
```
